```python
import torch

def _softmax(x, axis=-1):
    return torch.softmax(x, dim=axis)
def _gelu(x):
    return torch.nn.functional.gelu(x, approximate="tanh")
def _silu(x):
    return torch.nn.functional.silu(x)
def _sigmoid(x):
    return torch.sigmoid(x)
def _layernorm(x, axis=-1, eps=1e-5):
    m = x.mean(dim=axis, keepdim=True)
    v = x.var(dim=axis, keepdim=True, unbiased=False)
    return (x - m) / torch.sqrt(v + eps)
def _scatter_add(tgt, idx, src, axis=0):
    return tgt.clone().index_add_(axis, idx, src)
def _segment_sum(src, seg, n):
    out = torch.zeros((n,) + src.shape[1:], dtype=src.dtype)
    return out.index_add_(0, seg, src)
def _pad(x, pw):
    flat = tuple(v for pair in reversed(pw) for v in pair)
    return torch.nn.functional.pad(x, flat)

kernel_name = 'sequential_preLN__linear_attn_block__dense_activation_relu__prompt'

def setup_inputs():

    _w = (lambda a: (lambda t: t.to(torch.bfloat16) if t.is_floating_point() else t)(torch.as_tensor(a)))
    def _A_setup():
        B, S, D = 1, 2048, 576
        return {
            "x": _w((lambda *s: torch.randn(*s, dtype=torch.bfloat16) * 0.05)(B, S, D)),
            "wqkv": _w((lambda *s: torch.randn(*s, dtype=torch.bfloat16) * 0.05)(D, 3 * D)),
            "wo": _w((lambda *s: torch.randn(*s, dtype=torch.bfloat16) * 0.05)(D, D)),
        }
    _A_in = _A_setup()

    def _B_setup():
        B, S, D, Dff = 1, 2048, 576, 4608
        return {
            "x": _w((lambda *s: torch.randn(*s, dtype=torch.bfloat16) * 0.05)(B, S, D)),
            "w1": _w((lambda *s: torch.randn(*s, dtype=torch.bfloat16) * 0.05)(D, Dff)),
            "w2": _w((lambda *s: torch.randn(*s, dtype=torch.bfloat16) * 0.05)(Dff, D)),
        }
    _B_in = _B_setup()

    return {
        "A_x": _A_in["x"],
        "A_wqkv": _A_in["wqkv"],
        "A_wo": _A_in["wo"],
        "B_x": _B_in["x"],
        "B_w1": _B_in["w1"],
        "B_w2": _B_in["w2"],
    }

def reference(A_x, A_wqkv, A_wo, B_x, B_w1, B_w2):
    def _A_ref(x, wqkv, wo):
        B, S, D = x.shape
        H = 32; Dh = D // H
        qkv = (lambda x, *d: x.permute(*d))((x @ wqkv).reshape(B, S, 3, H, Dh), 2, 0, 3, 1, 4)
        q, k, v = qkv[0], qkv[1], qkv[2]
        phi = lambda t: torch.where(t > 0, t + 1, torch.exp(t)) + 1e-6
        pq, pk = phi(q), phi(k)
        kv = torch.einsum("bhsd,bhse->bhde", pk, v)
        z = torch.einsum("bhsd->bhd", pk)
        num = torch.einsum("bhqd,bhde->bhqe", pq, kv)
        den = torch.einsum("bhqd,bhd->bhq", pq, z)[..., None] + 1e-6
        o = num / den
        return (lambda x, *d: x.permute(*d))(o, 0, 2, 1, 3).reshape(B, S, D) @ wo

    def _B_ref(x, w1, w2):
        h = torch.einsum("bsd,df->bsf", x, w1)
        zero = torch.zeros_like(h)
        h = torch.maximum(h, zero)
        return torch.einsum("bsf,fd->bsd", h, w2)

    x = A_x
    h = x + _A_ref(_layernorm(x, axis=-1), A_wqkv, A_wo)
    h2 = h + _B_ref(_layernorm(h, axis=-1), B_w1, B_w2)
    return h2
```

```asm
; @launch kernel=qkv_kernel grid=(256,1,1) block=(512,1,1) lds=163840
; @launch kernel=sequential_preLN__linear_attn_block__dense_activation_relu__prompt_kernel grid=(256,1,1) block=(256,1,1) lds=163840
.amdgcn_target "amdgcn-amd-amdhsa--gfx950"
.text
.globl qkv_kernel
.p2align 8
.type qkv_kernel,@function
qkv_kernel:
    s_cmp_ge_u32 s2, 256
    s_cbranch_scc1 L_exit_1
    s_load_dwordx4 s[56:59], s[0:1], 0
    s_load_dwordx2 s[60:61], s[0:1], 16
    s_load_dwordx4 s[4:7], s[0:1], 56
    s_load_dwordx4 s[64:67], s[0:1], 32
    v_lshrrev_b32 v120, 6, v0
    v_and_b32 v0, 63, v0
    v_readfirstlane_b32 s38, v120
    s_lshr_b32 s46, s2, 1
    s_and_b32 s46, s46, 3
    s_lshl_b32 s46, s46, 2
    s_lshr_b32 s47, s2, 6
    s_add_u32 s36, s46, s47
    s_and_b32 s46, s2, 1
    s_lshl_b32 s46, s46, 3
    s_bfe_u32 s47, s2, 0x30003
    s_add_u32 s37, s46, s47
    v_lshrrev_b32 v120, 3, v0
    v_lshrrev_b32 v17, 4, v0
    v_and_b32 v121, 7, v0
    v_xor_b32 v122, v121, v17
    v_mul_u32_u24 v123, 1152, v120
    v_lshl_add_u32 v1, v122, 4, v123
    v_xor_b32 v2, 64, v1
    v_xor_b32 v122, 4, v122
    v_lshl_add_u32 v2, v122, 4, v123
    v_add_u32 v2, 8192, v2
    v_and_b32 v122, 6, v120
    v_xor_b32 v122, v122, v121
    v_and_b32 v123, 4, v120
    v_add_u32 v123, v123, v120
    v_mul_u32_u24 v123, 3456, v123
    v_lshl_add_u32 v3, v122, 4, v123
    v_add_u32 v4, 128, v3
    v_add_u32 v5, 256, v3
    s_lshl_b32 s46, s36, 3
    s_add_u32 s46, s46, s38
    s_mul_i32 s39, s46, 18432
    s_lshl_b32 s41, s38, 11
    s_mul_i32 s42, s38, 3072
    s_add_u32 s42, s42, 16384
    s_lshr_b32 s46, s38, 1
    s_lshl_b32 s46, s46, 2
    s_and_b32 s47, s38, 1
    s_add_u32 s46, s46, s47
    s_mul_i32 s40, s46, 13824
    s_mul_i32 s49, s37, 72
    s_andn2_b32 s47, s49, 63
    s_add_u32 s40, s40, s47
    s_and_b32 s49, s49, 63
    s_mov_b32 s45, 0
    v_lshlrev_b32 v18, 4, v0
    s_waitcnt lgkmcnt(0)
    s_mov_b32 s8, s56
    s_mov_b32 s9, s57
    s_mov_b32 s10, 2359296
    s_mov_b32 s11, 0x00020000
    s_mov_b32 s12, s58
    s_mov_b32 s13, s59
    s_mov_b32 s14, 1990656
    s_mov_b32 s15, 0x00020000
    s_mov_b32 s16, s6
    s_mov_b32 s17, s7
    s_mov_b32 s18, 23942144
    s_mov_b32 s19, 0x00020000
    s_mul_i32 s48, s37, 3072
    s_or_b32 s46, s36, s38
    s_cbranch_scc1 L_nozero_2
    v_mov_b32 v124, 0
    v_mov_b32 v125, 0
    v_mov_b32 v126, 0
    v_mov_b32 v127, 0
    s_add_u32 s46, s48, 23592960
    v_lshlrev_b32 v126, 3, v0
    buffer_atomic_and_x2 v[124:125], v126, s[16:19], s46 offen offset:0 sc1
    buffer_atomic_and_x2 v[124:125], v126, s[16:19], s46 offen offset:512 sc1
    buffer_atomic_and_x2 v[124:125], v126, s[16:19], s46 offen offset:1024 sc1
    buffer_atomic_and_x2 v[124:125], v126, s[16:19], s46 offen offset:1536 sc1
    buffer_atomic_and_x2 v[124:125], v126, s[16:19], s46 offen offset:2048 sc1
    buffer_atomic_and_x2 v[124:125], v126, s[16:19], s46 offen offset:2560 sc1
    s_lshl_b32 s46, s37, 11
    s_add_u32 s46, s46, 23811072
    v_lshlrev_b32 v126, 3, v121
    v_lshl_add_u32 v126, v120, 7, v126
    buffer_atomic_and_x2 v[124:125], v126, s[16:19], s46 offen offset:0 sc1
    buffer_atomic_and_x2 v[124:125], v126, s[16:19], s46 offen offset:1024 sc1
L_nozero_2:
    s_cmp_eq_u32 s38, 5
    s_cselect_b32 s46, s2, 255
    s_cmp_ge_u32 s46, 72
    s_mov_b32 s28, s60
    s_mov_b32 s29, s61
    s_mov_b32 s30, 663552
    s_mov_b32 s31, 0x00020000
    s_cbranch_scc1 L_nors_3
    v_mul_u32_u24 v124, 1152, v120
    v_lshl_add_u32 v124, v121, 4, v124
    s_mul_i32 s46, s2, 9216
    buffer_load_dwordx4 v[160:163], v124, s[28:31], s46 offen offset:0
    buffer_load_dwordx4 v[164:167], v124, s[28:31], s46 offen offset:128
    buffer_load_dwordx4 v[168:171], v124, s[28:31], s46 offen offset:256
    buffer_load_dwordx4 v[172:175], v124, s[28:31], s46 offen offset:384
    buffer_load_dwordx4 v[176:179], v124, s[28:31], s46 offen offset:512
    buffer_load_dwordx4 v[180:183], v124, s[28:31], s46 offen offset:640
    buffer_load_dwordx4 v[184:187], v124, s[28:31], s46 offen offset:768
    buffer_load_dwordx4 v[188:191], v124, s[28:31], s46 offen offset:896
    buffer_load_dwordx4 v[192:195], v124, s[28:31], s46 offen offset:1024
L_nors_3:
    s_add_u32 m0, s45, s41
    s_add_u32 s46, s45, s42
    buffer_load_dwordx4 v1, s[8:11], s39 offen lds
    buffer_load_dwordx4 v2, s[8:11], s39 offen offset:1024 lds
    s_mov_b32 m0, s46
    s_add_u32 s39, s39, 128
    buffer_load_dwordx4 v3, s[12:15], s40 offen offset:0 lds
    buffer_load_dwordx4 v4, s[12:15], s40 offen offset:1024 lds
    buffer_load_dwordx4 v5, s[12:15], s40 offen offset:2048 lds
    s_add_u32 s40, s40, 221184
    s_add_u32 s45, s45, 40960
    s_cmp_eq_u32 s45, 163840
    s_cselect_b32 s45, 0, s45
    s_barrier
    s_add_u32 m0, s45, s41
    s_add_u32 s46, s45, s42
    buffer_load_dwordx4 v1, s[8:11], s39 offen lds
    buffer_load_dwordx4 v2, s[8:11], s39 offen offset:1024 lds
    s_mov_b32 m0, s46
    s_add_u32 s39, s39, 128
    buffer_load_dwordx4 v3, s[12:15], s40 offen offset:0 lds
    buffer_load_dwordx4 v4, s[12:15], s40 offen offset:1024 lds
    buffer_load_dwordx4 v5, s[12:15], s40 offen offset:2048 lds
    s_add_u32 s40, s40, 221184
    s_add_u32 s45, s45, 40960
    s_cmp_eq_u32 s45, 163840
    s_cselect_b32 s45, 0, s45
    v_lshlrev_b32 v116, 7, v0
    s_mov_b32 s66, 5308416
    s_mov_b32 s67, 0x00020000
    s_add_u32 m0, s45, s41
    s_add_u32 s46, s45, s42
    buffer_load_dwordx4 v1, s[8:11], s39 offen lds
    buffer_load_dwordx4 v2, s[8:11], s39 offen offset:1024 lds
    s_mov_b32 m0, s46
    s_add_u32 s39, s39, 128
    buffer_load_dwordx4 v3, s[12:15], s40 offen offset:0 lds
    buffer_load_dwordx4 v4, s[12:15], s40 offen offset:1024 lds
    buffer_load_dwordx4 v5, s[12:15], s40 offen offset:2048 lds
    s_add_u32 s40, s40, 221184
    s_add_u32 s45, s45, 40960
    s_cmp_eq_u32 s45, 163840
    s_cselect_b32 s45, 0, s45
    s_cmp_lt_u32 s38, 6
    s_cselect_b64 s[32:33], s[12:13], s[8:9]
    s_cselect_b32 s34, s14, s10
    s_mov_b32 s35, 0x00020000
    s_cselect_b32 s46, 52, 43
    s_cselect_b32 s47, 5, 6
    s_cselect_b32 s54, 30, 48
    v_mul_u32_u24 v124, s46, v0
    v_lshrrev_b32 v124, 8, v124
    v_mul_u32_u24 v125, s47, v124
    v_sub_u32 v125, v0, v125
    v_mul_u32_u24 v124, 1152, v124
    v_lshl_add_u32 v124, v125, 7, v124
    s_lshr_b32 s46, s2, 3
    s_mul_i32 s47, s46, 6
    s_add_u32 s47, s47, s38
    s_mul_i32 s47, s47, 6912
    s_and_b32 s62, s2, 1
    s_lshl_b32 s62, s62, 9
    s_add_u32 s47, s47, s62
    s_add_u32 s47, s47, 663552
    s_bfe_u32 s62, s2, 0x20001
    s_lshl_b32 s62, s62, 5
    s_add_u32 s46, s46, s62
    s_lshl_b32 s46, s46, 1
    s_add_u32 s46, s46, s38
    s_mul_i32 s46, s46, 9216
    s_sub_u32 s46, s46, 54912
    s_cmp_lt_u32 s38, 6
    s_cselect_b32 s46, s47, s46
    s_bfm_b64 exec, s54, 0
    buffer_load_dword v117, v124, s[32:35], s46 offen
    s_mov_b64 exec, -1
    s_mov_b32 s24, s4
    s_mov_b32 s25, s5
    s_mov_b32 s26, 256
    s_mov_b32 s27, 0x00020000
    s_and_b32 s46, s38, 1
    s_mul_i32 s46, s46, 1536
    s_add_u32 s48, s48, s46
    s_add_u32 s20, s6, s48
    s_addc_u32 s21, s7, 0
    s_add_u32 s20, s20, 23592960
    s_addc_u32 s21, s21, 0
    s_mov_b32 s22, 1536
    s_mov_b32 s23, 0x00020000
    s_mov_b32 s50, 0x358637bd
    s_mov_b32 s51, 0x358637bd
    s_mov_b32 s52, 0x3fb8aa3b
    s_mov_b32 s53, 0x3fb8aa3b
    v_and_b32 v16, 15, v0
    v_lshrrev_b32 v120, 1, v16
    v_xor_b32 v120, v120, v17
    v_lshlrev_b32 v120, 4, v120
    v_lshl_add_u32 v120, v16, 7, v120
    s_and_b32 s46, s38, 3
    s_lshl_b32 s46, s46, 12
    v_add_u32 v6, s46, v120
    v_xor_b32 v7, 64, v6
    v_bfe_u32 v120, v0, 2, 3
    v_lshrrev_b32 v121, 5, v0
    v_mul_u32_u24 v121, 6144, v121
    v_lshl_add_u32 v121, v120, 7, v121
    v_add_u32 v121, 16384, v121
    v_and_b32 v120, 6, v120
    v_lshlrev_b32 v120, 4, v120
    v_and_b32 v122, 3, v0
    v_lshl_add_u32 v123, v122, 3, s49
    v_xor_b32 v124, v123, v120
    v_add_u32 v8, v124, v121
    v_add_u32 v123, 40, v123
    v_xor_b32 v124, v123, v120
    v_add_u32 v9, v124, v121
    s_add_u32 s46, s49, 32
    v_xor_b32 v124, s46, v120
    v_min_u32 v122, 2, v122
    v_lshl_add_u32 v124, v122, 10, v124
    v_add_u32 v10, v124, v121
    s_movk_i32 s46, 0x2c
    s_lshr_b32 s46, s46, s38
    s_bitcmp1_b32 s46, 0
    s_cselect_b64 vcc, -1, 0
    v_cndmask_b32 v11, v8, v9, vcc
    s_and_b32 s46, s38, 1
    s_add_u32 s46, s46, 1
    s_lshl_b32 s46, s46, 10
    s_cmp_lt_u32 s38, 4
    s_cselect_b32 s46, s46, 0
    v_add_u32 v11, s46, v11
    s_cmp_ge_u32 s38, 6
    s_cselect_b64 vcc, -1, 0
    v_cndmask_b32 v11, v11, v10, vcc
    s_and_b32 s47, s38, 1
    s_lshl_b32 s47, s47, 1
    v_lshl_add_u32 v12, v17, 2, 0
    v_lshl_add_u32 v13, v17, 2, 1
    v_lshl_add_u32 v14, v17, 2, 2
    v_lshl_add_u32 v15, v17, 2, 3
    s_bitcmp1_b32 s38, 1
    s_cbranch_scc0 L_noa_5
    s_add_u32 s46, s47, 8
    v_mov_b32 v121, 0x1000
    v_subrev_u32 v120, s46, v12
    v_cmp_gt_u32 vcc, 2, v120
    v_add_u32 v120, 16, v120
    v_cndmask_b32 v120, v121, v120, vcc
    v_cmp_ne_u32 vcc, 12, v12
    v_cndmask_b32 v12, 18, v120, vcc
    v_subrev_u32 v120, s46, v13
    v_cmp_gt_u32 vcc, 2, v120
    v_add_u32 v120, 16, v120
    v_cndmask_b32 v120, v121, v120, vcc
    v_cmp_ne_u32 vcc, 12, v13
    v_cndmask_b32 v13, 18, v120, vcc
    v_subrev_u32 v120, s46, v14
    v_cmp_gt_u32 vcc, 2, v120
    v_add_u32 v120, 16, v120
    v_cndmask_b32 v120, v121, v120, vcc
    v_cmp_ne_u32 vcc, 12, v14
    v_cndmask_b32 v14, 18, v120, vcc
    v_subrev_u32 v120, s46, v15
    v_cmp_gt_u32 vcc, 2, v120
    v_add_u32 v120, 16, v120
    v_cndmask_b32 v120, v121, v120, vcc
    v_cmp_ne_u32 vcc, 12, v15
    v_cndmask_b32 v15, 18, v120, vcc
L_noa_5:
    s_bitcmp1_b32 s38, 2
    s_cbranch_scc0 L_nob_6
    s_add_u32 s46, s47, 4
    v_subrev_u32 v120, s46, v16
    v_lshrrev_b32 v121, 1, v120
    v_cmp_eq_u32 vcc, 1, v121
    v_cndmask_b32 v12, v12, v13, vcc
    v_cmp_eq_u32 vcc, 2, v121
    v_cndmask_b32 v12, v12, v14, vcc
    v_cmp_eq_u32 vcc, 3, v121
    v_cndmask_b32 v12, v12, v15, vcc
    v_mov_b32 v13, v121
    v_cmp_gt_u32 vcc, 8, v120
    v_and_b32 v120, 1, v120
    v_lshlrev_b32 v120, 2, v120
    v_add_u32 v120, 1280, v120
    v_mov_b32 v121, 0x10000
    v_cndmask_b32 v120, v121, v120, vcc
    v_lshl_add_u32 v12, v12, 3, v120
    s_branch L_jb_7
L_nob_6:
    v_lshlrev_b32 v120, 2, v16
    v_lshl_add_u32 v12, v12, 6, v120
    v_lshl_add_u32 v13, v13, 6, v120
    v_lshl_add_u32 v14, v14, 6, v120
    v_lshl_add_u32 v15, v15, 6, v120
L_jb_7:
    s_bfe_u32 s55, s2, 0x30003
    s_mul_i32 s55, s55, 144
    s_lshl_b32 s62, s38, 10
    s_movk_i32 s63, 1152
    s_lshl_b32 s46, s38, 6
    v_add_u32 v120, s46, v0
    v_mul_u32_u24 v121, 6554, v120
    v_lshrrev_b32 v121, 16, v121
    v_mad_i32_i24 v120, v121, -10, v120
    v_min_u32 v120, 8, v120
    v_lshlrev_b32 v120, 4, v120
    v_mad_u32_u24 v204, v121, s63, v120
    s_add_u32 s46, s46, 512
    v_add_u32 v120, s46, v0
    v_mul_u32_u24 v121, 6554, v120
    v_lshrrev_b32 v121, 16, v121
    v_mad_i32_i24 v120, v121, -10, v120
    v_min_u32 v120, 8, v120
    v_lshlrev_b32 v120, 4, v120
    v_mad_u32_u24 v205, v121, s63, v120
    s_add_u32 s46, s46, 512
    v_add_u32 v120, s46, v0
    v_mul_u32_u24 v121, 6554, v120
    v_lshrrev_b32 v121, 16, v121
    v_mad_i32_i24 v120, v121, -10, v120
    v_min_u32 v120, 8, v120
    v_lshlrev_b32 v120, 4, v120
    v_mad_u32_u24 v206, v121, s63, v120
    s_add_u32 s46, s46, 512
    v_add_u32 v120, s46, v0
    v_mul_u32_u24 v121, 6554, v120
    v_lshrrev_b32 v121, 16, v121
    v_mad_i32_i24 v120, v121, -10, v120
    v_min_u32 v120, 8, v120
    v_lshlrev_b32 v120, 4, v120
    v_mad_u32_u24 v207, v121, s63, v120
    s_add_u32 s46, s46, 512
    v_add_u32 v120, s46, v0
    v_mul_u32_u24 v121, 6554, v120
    v_lshrrev_b32 v121, 16, v121
    v_mad_i32_i24 v120, v121, -10, v120
    v_min_u32 v120, 8, v120
    v_lshlrev_b32 v120, 4, v120
    v_mad_u32_u24 v208, v121, s63, v120
    s_add_u32 s46, s46, 512
    v_mov_b32 v20, 0x3f803f80
    v_mov_b32 v21, 0x3f803f80
    v_mov_b32 v22, 0x3f803f80
    v_mov_b32 v23, 0x3f803f80
    v_mov_b32 v119, 0
    v_mov_b64 v[32:33], 0
    v_mov_b64 v[34:35], 0
    v_mov_b64 v[36:37], 0
    v_mov_b64 v[38:39], 0
    v_mov_b64 v[60:61], 0
    v_mov_b64 v[62:63], 0
    v_mov_b64 v[64:65], 0
    v_mov_b64 v[66:67], 0
    v_mov_b64 v[68:69], 0
    v_mov_b64 v[70:71], 0
    v_mov_b64 v[72:73], 0
    v_mov_b64 v[74:75], 0
    v_mov_b64 v[76:77], 0
    v_mov_b64 v[78:79], 0
    v_mov_b64 v[80:81], 0
    v_mov_b64 v[82:83], 0
    v_mov_b64 v[84:85], 0
    v_mov_b64 v[86:87], 0
    v_mov_b64 v[88:89], 0
    v_mov_b64 v[90:91], 0
    v_mov_b64 v[92:93], 0
    v_mov_b64 v[94:95], 0
    v_mov_b64 v[96:97], 0
    v_mov_b64 v[98:99], 0
    v_mov_b64 v[100:101], 0
    v_mov_b64 v[102:103], 0
    v_mov_b64 v[104:105], 0
    v_mov_b64 v[106:107], 0
    v_mov_b64 v[108:109], 0
    v_mov_b64 v[110:111], 0
    v_mov_b64 v[112:113], 0
    v_mov_b64 v[114:115], 0
    v_mov_b64 v[196:197], 0
    v_mov_b64 v[198:199], 0
    v_mov_b64 v[200:201], 0
    v_mov_b64 v[202:203], 0
    s_or_b32 s46, s36, s38
    s_cbranch_scc1 L_nof_4
    s_lshl_b32 s46, s37, 10
    s_add_u32 s46, s46, 23794688
    v_mov_b32 v121, 0
    buffer_store_dwordx4 v[80:83], v18, s[16:19], s46 offen
    v_mov_b32 v122, 1
    s_waitcnt vmcnt(12)
    s_mov_b64 exec, 1
    buffer_store_byte v122, v121, s[24:27], s37 offen sc1
    s_mov_b64 exec, -1
L_nof_4:
    s_mov_b32 s43, 0
    s_cmp_ge_u32 s38, 4
    s_cbranch_scc1 L_q_8
    s_waitcnt vmcnt(11)
    s_barrier
    v_mfma_f32_16x16x32_bf16 v[80:83], v[32:35], v[60:63], v[80:83]
    ds_read_b128 v[24:27], v6 offset:0
    ds_read_b128 v[28:31], v6 offset:2048
    v_mfma_f32_16x16x32_bf16 v[84:87], v[36:39], v[60:63], v[84:87]
    ds_read_b64_tr_b16 v[40:41], v8 offset:1024
    ds_read_b64_tr_b16 v[42:43], v8 offset:4096
    v_mfma_f32_16x16x32_bf16 v[88:91], v[32:35], v[64:67], v[88:91]
    ds_read_b64_tr_b16 v[44:45], v8 offset:2048
    ds_read_b64_tr_b16 v[46:47], v8 offset:5120
    v_mfma_f32_16x16x32_bf16 v[92:95], v[36:39], v[64:67], v[92:95]
    ds_read_b64_tr_b16 v[48:49], v9 offset:1024
    ds_read_b64_tr_b16 v[50:51], v9 offset:4096
    v_mfma_f32_16x16x32_bf16 v[96:99], v[32:35], v[68:71], v[96:99]
    ds_read_b64_tr_b16 v[52:53], v9 offset:2048
    ds_read_b64_tr_b16 v[54:55], v9 offset:5120
    s_add_u32 m0, s45, s41
    s_add_u32 s46, s45, s42
    buffer_load_dwordx4 v1, s[8:11], s39 offen lds
    v_mfma_f32_16x16x32_bf16 v[100:103], v[36:39], v[68:71], v[100:103]
    ds_read_b64_tr_b16 v[56:57], v11 offset:0
    ds_read_b64_tr_b16 v[58:59], v11 offset:3072
    v_mfma_f32_16x16x32_bf16 v[104:107], v[32:35], v[72:75], v[104:107]
    buffer_load_dwordx4 v2, s[8:11], s39 offen offset:1024 lds
    s_mov_b32 m0, s46
    s_add_u32 s39, s39, 128
    v_mfma_f32_16x16x32_bf16 v[108:111], v[36:39], v[72:75], v[108:111]
    v_mfma_f32_16x16x32_bf16 v[112:115], v[20:23], v[76:79], v[112:115]
    buffer_load_dwordx4 v3, s[12:15], s40 offen lds
    s_waitcnt lgkmcnt(0)
    v_mfma_f32_16x16x32_bf16 v[80:83], v[24:27], v[40:43], v[80:83]
    ds_read_b128 v[32:35], v7 offset:0
    ds_read_b128 v[36:39], v7 offset:2048
    v_mfma_f32_16x16x32_bf16 v[84:87], v[28:31], v[40:43], v[84:87]
    ds_read_b64_tr_b16 v[60:61], v8 offset:13312
    ds_read_b64_tr_b16 v[62:63], v8 offset:16384
    v_mfma_f32_16x16x32_bf16 v[88:91], v[24:27], v[44:47], v[88:91]
    ds_read_b64_tr_b16 v[64:65], v8 offset:14336
    ds_read_b64_tr_b16 v[66:67], v8 offset:17408
    v_mfma_f32_16x16x32_bf16 v[92:95], v[28:31], v[44:47], v[92:95]
    ds_read_b64_tr_b16 v[68:69], v9 offset:13312
    ds_read_b64_tr_b16 v[70:71], v9 offset:16384
    v_mfma_f32_16x16x32_bf16 v[96:99], v[24:27], v[48:51], v[96:99]
    ds_read_b64_tr_b16 v[72:73], v9 offset:14336
    ds_read_b64_tr_b16 v[74:75], v9 offset:17408
    v_mfma_f32_16x16x32_bf16 v[100:103], v[28:31], v[48:51], v[100:103]
    ds_read_b64_tr_b16 v[76:77], v11 offset:12288
    ds_read_b64_tr_b16 v[78:79], v11 offset:15360
    buffer_load_dwordx4 v4, s[12:15], s40 offen offset:1024 lds
    v_mfma_f32_16x16x32_bf16 v[104:107], v[24:27], v[52:55], v[104:107]
    v_mfma_f32_16x16x32_bf16 v[108:111], v[28:31], v[52:55], v[108:111]
    buffer_load_dwordx4 v5, s[12:15], s40 offen offset:2048 lds
    s_add_u32 s40, s40, 221184
    s_add_u32 s45, s45, 40960
    s_cmp_eq_u32 s45, 163840
    s_cselect_b32 s45, 0, s45
    v_mfma_f32_16x16x32_bf16 v[112:115], v[20:23], v[56:59], v[112:115]
    v_add_u32 v6, 40960, v6
    v_add_u32 v7, 40960, v7
    v_add_u32 v8, 40960, v8
    v_add_u32 v9, 40960, v9
    v_add_u32 v11, 40960, v11
    s_mov_b32 s43, 1
L_slot_11:
    s_cmp_eq_u32 s43, 3
    s_mov_b32 s44, 40960
    s_cselect_b32 s44, 4294844416, s44
    s_add_u32 s43, s43, 1
    s_waitcnt vmcnt(10) lgkmcnt(0)
    s_barrier
    v_mfma_f32_16x16x32_bf16 v[80:83], v[32:35], v[60:63], v[80:83]
    ds_read_b128 v[24:27], v6 offset:0
    ds_read_b128 v[28:31], v6 offset:2048
    v_mfma_f32_16x16x32_bf16 v[84:87], v[36:39], v[60:63], v[84:87]
    ds_read_b64_tr_b16 v[40:41], v8 offset:1024
    ds_read_b64_tr_b16 v[42:43], v8 offset:4096
    v_mfma_f32_16x16x32_bf16 v[88:91], v[32:35], v[64:67], v[88:91]
    ds_read_b64_tr_b16 v[44:45], v8 offset:2048
    ds_read_b64_tr_b16 v[46:47], v8 offset:5120
    v_mfma_f32_16x16x32_bf16 v[92:95], v[36:39], v[64:67], v[92:95]
    ds_read_b64_tr_b16 v[48:49], v9 offset:1024
    ds_read_b64_tr_b16 v[50:51], v9 offset:4096
    v_mfma_f32_16x16x32_bf16 v[96:99], v[32:35], v[68:71], v[96:99]
    ds_read_b64_tr_b16 v[52:53], v9 offset:2048
    ds_read_b64_tr_b16 v[54:55], v9 offset:5120
    s_add_u32 m0, s45, s41
    s_add_u32 s46, s45, s42
    buffer_load_dwordx4 v1, s[8:11], s39 offen lds
    v_mfma_f32_16x16x32_bf16 v[100:103], v[36:39], v[68:71], v[100:103]
    ds_read_b64_tr_b16 v[56:57], v11 offset:0
    ds_read_b64_tr_b16 v[58:59], v11 offset:3072
    v_mfma_f32_16x16x32_bf16 v[104:107], v[32:35], v[72:75], v[104:107]
    buffer_load_dwordx4 v2, s[8:11], s39 offen offset:1024 lds
    s_mov_b32 m0, s46
    s_add_u32 s39, s39, 128
    v_mfma_f32_16x16x32_bf16 v[108:111], v[36:39], v[72:75], v[108:111]
    v_mfma_f32_16x16x32_bf16 v[112:115], v[20:23], v[76:79], v[112:115]
    buffer_load_dwordx4 v3, s[12:15], s40 offen lds
    s_waitcnt lgkmcnt(0)
    v_mfma_f32_16x16x32_bf16 v[80:83], v[24:27], v[40:43], v[80:83]
    ds_read_b128 v[32:35], v7 offset:0
    ds_read_b128 v[36:39], v7 offset:2048
    v_mfma_f32_16x16x32_bf16 v[84:87], v[28:31], v[40:43], v[84:87]
    ds_read_b64_tr_b16 v[60:61], v8 offset:13312
    ds_read_b64_tr_b16 v[62:63], v8 offset:16384
    v_mfma_f32_16x16x32_bf16 v[88:91], v[24:27], v[44:47], v[88:91]
    ds_read_b64_tr_b16 v[64:65], v8 offset:14336
    ds_read_b64_tr_b16 v[66:67], v8 offset:17408
    v_mfma_f32_16x16x32_bf16 v[92:95], v[28:31], v[44:47], v[92:95]
    ds_read_b64_tr_b16 v[68:69], v9 offset:13312
    ds_read_b64_tr_b16 v[70:71], v9 offset:16384
    v_mfma_f32_16x16x32_bf16 v[96:99], v[24:27], v[48:51], v[96:99]
    ds_read_b64_tr_b16 v[72:73], v9 offset:14336
    ds_read_b64_tr_b16 v[74:75], v9 offset:17408
    v_mfma_f32_16x16x32_bf16 v[100:103], v[28:31], v[48:51], v[100:103]
    ds_read_b64_tr_b16 v[76:77], v11 offset:12288
    ds_read_b64_tr_b16 v[78:79], v11 offset:15360
    buffer_load_dwordx4 v4, s[12:15], s40 offen offset:1024 lds
    v_mfma_f32_16x16x32_bf16 v[104:107], v[24:27], v[52:55], v[104:107]
    v_mfma_f32_16x16x32_bf16 v[108:111], v[28:31], v[52:55], v[108:111]
    buffer_load_dwordx4 v5, s[12:15], s40 offen offset:2048 lds
    s_add_u32 s40, s40, 221184
    s_add_u32 s45, s45, 40960
    s_cmp_eq_u32 s45, 163840
    s_cselect_b32 s45, 0, s45
    v_mfma_f32_16x16x32_bf16 v[112:115], v[20:23], v[56:59], v[112:115]
    v_add_u32 v6, s44, v6
    v_add_u32 v7, s44, v7
    v_add_u32 v8, s44, v8
    v_add_u32 v9, s44, v9
    v_add_u32 v11, s44, v11
    s_cmp_lt_u32 s43, 6
    s_cbranch_scc1 L_slot_11
    s_waitcnt vmcnt(10) lgkmcnt(0)
    buffer_load_ubyte v19, v16, s[24:27], 0 offen sc1
    s_barrier
    v_mfma_f32_16x16x32_bf16 v[80:83], v[32:35], v[60:63], v[80:83]
    ds_read_b128 v[24:27], v6 offset:0
    ds_read_b128 v[28:31], v6 offset:2048
    v_mfma_f32_16x16x32_bf16 v[84:87], v[36:39], v[60:63], v[84:87]
    ds_read_b64_tr_b16 v[40:41], v8 offset:1024
    ds_read_b64_tr_b16 v[42:43], v8 offset:4096
    v_mfma_f32_16x16x32_bf16 v[88:91], v[32:35], v[64:67], v[88:91]
    ds_read_b64_tr_b16 v[44:45], v8 offset:2048
    ds_read_b64_tr_b16 v[46:47], v8 offset:5120
    v_mfma_f32_16x16x32_bf16 v[92:95], v[36:39], v[64:67], v[92:95]
    ds_read_b64_tr_b16 v[48:49], v9 offset:1024
    ds_read_b64_tr_b16 v[50:51], v9 offset:4096
    v_mfma_f32_16x16x32_bf16 v[96:99], v[32:35], v[68:71], v[96:99]
    ds_read_b64_tr_b16 v[52:53], v9 offset:2048
    ds_read_b64_tr_b16 v[54:55], v9 offset:5120
    s_add_u32 m0, s62, 65536
    s_nop 0
    buffer_load_dwordx4 v204, s[28:31], s55 offen lds
    v_mfma_f32_16x16x32_bf16 v[100:103], v[36:39], v[68:71], v[100:103]
    ds_read_b64_tr_b16 v[56:57], v11 offset:0
    ds_read_b64_tr_b16 v[58:59], v11 offset:3072
    v_mfma_f32_16x16x32_bf16 v[104:107], v[32:35], v[72:75], v[104:107]
    s_add_u32 m0, s62, 73728
    s_nop 0
    buffer_load_dwordx4 v205, s[28:31], s55 offen lds
    v_mfma_f32_16x16x32_bf16 v[108:111], v[36:39], v[72:75], v[108:111]
    v_mfma_f32_16x16x32_bf16 v[112:115], v[20:23], v[76:79], v[112:115]
    s_waitcnt lgkmcnt(0)
    v_mfma_f32_16x16x32_bf16 v[80:83], v[24:27], v[40:43], v[80:83]
    ds_read_b128 v[32:35], v7 offset:0
    ds_read_b128 v[36:39], v7 offset:2048
    v_mfma_f32_16x16x32_bf16 v[84:87], v[28:31], v[40:43], v[84:87]
    ds_read_b64_tr_b16 v[60:61], v8 offset:13312
    ds_read_b64_tr_b16 v[62:63], v8 offset:16384
    v_mfma_f32_16x16x32_bf16 v[88:91], v[24:27], v[44:47], v[88:91]
    ds_read_b64_tr_b16 v[64:65], v8 offset:14336
    ds_read_b64_tr_b16 v[66:67], v8 offset:17408
    v_mfma_f32_16x16x32_bf16 v[92:95], v[28:31], v[44:47], v[92:95]
    ds_read_b64_tr_b16 v[68:69], v9 offset:13312
    ds_read_b64_tr_b16 v[70:71], v9 offset:16384
    v_mfma_f32_16x16x32_bf16 v[96:99], v[24:27], v[48:51], v[96:99]
    ds_read_b64_tr_b16 v[72:73], v9 offset:14336
    ds_read_b64_tr_b16 v[74:75], v9 offset:17408
    v_mfma_f32_16x16x32_bf16 v[100:103], v[28:31], v[48:51], v[100:103]
    ds_read_b64_tr_b16 v[76:77], v11 offset:12288
    ds_read_b64_tr_b16 v[78:79], v11 offset:15360
    v_mfma_f32_16x16x32_bf16 v[104:107], v[24:27], v[52:55], v[104:107]
    v_mfma_f32_16x16x32_bf16 v[108:111], v[28:31], v[52:55], v[108:111]
    v_mfma_f32_16x16x32_bf16 v[112:115], v[20:23], v[56:59], v[112:115]
    v_add_u32 v6, 40960, v6
    v_add_u32 v7, 40960, v7
    v_add_u32 v8, 40960, v8
    v_add_u32 v9, 40960, v9
    v_add_u32 v11, 40960, v11
    s_waitcnt vmcnt(8) lgkmcnt(0)
    s_barrier
    v_mfma_f32_16x16x32_bf16 v[80:83], v[32:35], v[60:63], v[80:83]
    ds_read_b128 v[24:27], v6 offset:0
    ds_read_b128 v[28:31], v6 offset:2048
    v_mfma_f32_16x16x32_bf16 v[84:87], v[36:39], v[60:63], v[84:87]
    ds_read_b64_tr_b16 v[40:41], v8 offset:1024
    ds_read_b64_tr_b16 v[42:43], v8 offset:4096
    v_mfma_f32_16x16x32_bf16 v[88:91], v[32:35], v[64:67], v[88:91]
    ds_read_b64_tr_b16 v[44:45], v8 offset:2048
    ds_read_b64_tr_b16 v[46:47], v8 offset:5120
    v_mfma_f32_16x16x32_bf16 v[92:95], v[36:39], v[64:67], v[92:95]
    ds_read_b64_tr_b16 v[48:49], v9 offset:1024
    ds_read_b64_tr_b16 v[50:51], v9 offset:4096
    v_mfma_f32_16x16x32_bf16 v[96:99], v[32:35], v[68:71], v[96:99]
    ds_read_b64_tr_b16 v[52:53], v9 offset:2048
    ds_read_b64_tr_b16 v[54:55], v9 offset:5120
    s_add_u32 m0, s62, 81920
    s_nop 0
    buffer_load_dwordx4 v206, s[28:31], s55 offen lds
    v_mfma_f32_16x16x32_bf16 v[100:103], v[36:39], v[68:71], v[100:103]
    ds_read_b64_tr_b16 v[56:57], v11 offset:0
    ds_read_b64_tr_b16 v[58:59], v11 offset:3072
    v_mfma_f32_16x16x32_bf16 v[104:107], v[32:35], v[72:75], v[104:107]
    s_add_u32 m0, s62, 90112
    s_nop 0
    buffer_load_dwordx4 v207, s[28:31], s55 offen lds
    v_mfma_f32_16x16x32_bf16 v[108:111], v[36:39], v[72:75], v[108:111]
    v_mfma_f32_16x16x32_bf16 v[112:115], v[20:23], v[76:79], v[112:115]
    s_add_u32 m0, s62, 98304
    s_nop 0
    buffer_load_dwordx4 v208, s[28:31], s55 offen lds
    s_waitcnt lgkmcnt(0)
    v_mfma_f32_16x16x32_bf16 v[80:83], v[24:27], v[40:43], v[80:83]
    ds_read_b128 v[32:35], v7 offset:0
    ds_read_b128 v[36:39], v7 offset:2048
    v_mfma_f32_16x16x32_bf16 v[84:87], v[28:31], v[40:43], v[84:87]
    ds_read_b64_tr_b16 v[60:61], v8 offset:13312
    ds_read_b64_tr_b16 v[62:63], v8 offset:16384
    v_mfma_f32_16x16x32_bf16 v[88:91], v[24:27], v[44:47], v[88:91]
    ds_read_b64_tr_b16 v[64:65], v8 offset:14336
    ds_read_b64_tr_b16 v[66:67], v8 offset:17408
    v_mfma_f32_16x16x32_bf16 v[92:95], v[28:31], v[44:47], v[92:95]
    ds_read_b64_tr_b16 v[68:69], v9 offset:13312
    ds_read_b64_tr_b16 v[70:71], v9 offset:16384
    v_mfma_f32_16x16x32_bf16 v[96:99], v[24:27], v[48:51], v[96:99]
    ds_read_b64_tr_b16 v[72:73], v9 offset:14336
    ds_read_b64_tr_b16 v[74:75], v9 offset:17408
    v_mfma_f32_16x16x32_bf16 v[100:103], v[28:31], v[48:51], v[100:103]
    ds_read_b64_tr_b16 v[76:77], v11 offset:12288
    ds_read_b64_tr_b16 v[78:79], v11 offset:15360
    s_add_u32 m0, s62, 106496
    s_add_u32 s55, s55, 294912
    buffer_load_dwordx4 v204, s[28:31], s55 offen lds
    v_mfma_f32_16x16x32_bf16 v[104:107], v[24:27], v[52:55], v[104:107]
    v_mfma_f32_16x16x32_bf16 v[108:111], v[28:31], v[52:55], v[108:111]
    s_add_u32 m0, s62, 114688
    s_nop 0
    buffer_load_dwordx4 v205, s[28:31], s55 offen lds
    v_mfma_f32_16x16x32_bf16 v[112:115], v[20:23], v[56:59], v[112:115]
    v_add_u32 v6, 4294844416, v6
    v_add_u32 v7, 4294844416, v7
    v_add_u32 v8, 4294844416, v8
    v_add_u32 v9, 4294844416, v9
    v_add_u32 v11, 4294844416, v11
    s_waitcnt vmcnt(8) lgkmcnt(0)
    s_barrier
    v_mfma_f32_16x16x32_bf16 v[80:83], v[32:35], v[60:63], v[80:83]
    ds_read_b128 v[24:27], v6 offset:0
    ds_read_b128 v[28:31], v6 offset:2048
    v_mfma_f32_16x16x32_bf16 v[84:87], v[36:39], v[60:63], v[84:87]
    ds_read_b64_tr_b16 v[40:41], v8 offset:1024
    ds_read_b64_tr_b16 v[42:43], v8 offset:4096
    v_mfma_f32_16x16x32_bf16 v[88:91], v[32:35], v[64:67], v[88:91]
    ds_read_b64_tr_b16 v[44:45], v8 offset:2048
    ds_read_b64_tr_b16 v[46:47], v8 offset:5120
    v_mfma_f32_16x16x32_bf16 v[92:95], v[36:39], v[64:67], v[92:95]
    ds_read_b64_tr_b16 v[48:49], v9 offset:1024
    ds_read_b64_tr_b16 v[50:51], v9 offset:4096
    v_mfma_f32_16x16x32_bf16 v[96:99], v[32:35], v[68:71], v[96:99]
    ds_read_b64_tr_b16 v[52:53], v9 offset:2048
    ds_read_b64_tr_b16 v[54:55], v9 offset:5120
    s_add_u32 m0, s62, 122880
    s_nop 0
    buffer_load_dwordx4 v206, s[28:31], s55 offen lds
    v_mfma_f32_16x16x32_bf16 v[100:103], v[36:39], v[68:71], v[100:103]
    ds_read_b64_tr_b16 v[56:57], v11 offset:0
    ds_read_b64_tr_b16 v[58:59], v11 offset:3072
    v_mfma_f32_16x16x32_bf16 v[104:107], v[32:35], v[72:75], v[104:107]
    s_add_u32 m0, s62, 131072
    s_nop 0
    buffer_load_dwordx4 v207, s[28:31], s55 offen lds
    v_mfma_f32_16x16x32_bf16 v[108:111], v[36:39], v[72:75], v[108:111]
    v_mfma_f32_16x16x32_bf16 v[112:115], v[20:23], v[76:79], v[112:115]
    s_add_u32 m0, s62, 139264
    s_nop 0
    buffer_load_dwordx4 v208, s[28:31], s55 offen lds
    s_waitcnt lgkmcnt(0)
    v_mfma_f32_16x16x32_bf16 v[80:83], v[24:27], v[40:43], v[80:83]
    ds_read_b128 v[32:35], v7 offset:0
    ds_read_b128 v[36:39], v7 offset:2048
    v_mfma_f32_16x16x32_bf16 v[84:87], v[28:31], v[40:43], v[84:87]
    ds_read_b64_tr_b16 v[60:61], v8 offset:13312
    ds_read_b64_tr_b16 v[62:63], v8 offset:16384
    v_mfma_f32_16x16x32_bf16 v[88:91], v[24:27], v[44:47], v[88:91]
    ds_read_b64_tr_b16 v[64:65], v8 offset:14336
    ds_read_b64_tr_b16 v[66:67], v8 offset:17408
    v_mfma_f32_16x16x32_bf16 v[92:95], v[28:31], v[44:47], v[92:95]
    ds_read_b64_tr_b16 v[68:69], v9 offset:13312
    ds_read_b64_tr_b16 v[70:71], v9 offset:16384
    v_mfma_f32_16x16x32_bf16 v[96:99], v[24:27], v[48:51], v[96:99]
    ds_read_b64_tr_b16 v[72:73], v9 offset:14336
    ds_read_b64_tr_b16 v[74:75], v9 offset:17408
    v_mfma_f32_16x16x32_bf16 v[100:103], v[28:31], v[48:51], v[100:103]
    ds_read_b64_tr_b16 v[76:77], v11 offset:12288
    ds_read_b64_tr_b16 v[78:79], v11 offset:15360
    s_add_u32 m0, s62, 147456
    s_add_u32 s55, s55, 294912
    buffer_load_dwordx4 v204, s[28:31], s55 offen lds
    v_mfma_f32_16x16x32_bf16 v[104:107], v[24:27], v[52:55], v[104:107]
    v_mfma_f32_16x16x32_bf16 v[108:111], v[28:31], v[52:55], v[108:111]
    s_cmp_ge_u32 s38, 2
    s_cbranch_scc1 L_w11_12
    s_add_u32 m0, s62, 155648
    s_nop 0
    buffer_load_dwordx4 v205, s[28:31], s55 offen lds
    L_w11_12:
    v_mfma_f32_16x16x32_bf16 v[112:115], v[20:23], v[56:59], v[112:115]
    s_waitcnt vmcnt(11)
    s_lshl_b32 s46, s2, 3
    s_add_u32 s46, s46, s38
    s_mul_i32 s46, s46, 2592
    s_mov_b64 exec, 0x1fffff
    buffer_load_dword v117, v116, s[64:67], s46 offen
    s_mov_b64 exec, -1
    s_waitcnt lgkmcnt(0)
    v_mfma_f32_16x16x32_bf16 v[80:83], v[32:35], v[60:63], v[80:83]
    v_mfma_f32_16x16x32_bf16 v[84:87], v[36:39], v[60:63], v[84:87]
    v_mfma_f32_16x16x32_bf16 v[88:91], v[32:35], v[64:67], v[88:91]
    v_mfma_f32_16x16x32_bf16 v[92:95], v[36:39], v[64:67], v[92:95]
    v_mfma_f32_16x16x32_bf16 v[96:99], v[32:35], v[68:71], v[96:99]
    v_mfma_f32_16x16x32_bf16 v[100:103], v[36:39], v[68:71], v[100:103]
    v_mfma_f32_16x16x32_bf16 v[104:107], v[32:35], v[72:75], v[104:107]
    v_mfma_f32_16x16x32_bf16 v[108:111], v[36:39], v[72:75], v[108:111]
    v_mfma_f32_16x16x32_bf16 v[112:115], v[20:23], v[76:79], v[112:115]
    s_lshl_b32 s46, s38, 6
    v_lshl_add_u32 v120, v16, 2, s46
    s_nop 6
    ds_write_b32 v120, v112 offset:41984
    s_waitcnt lgkmcnt(0)
    s_barrier
    s_and_b32 s46, s38, 3
    s_lshl_b32 s46, s46, 7
    v_lshl_add_u32 v120, v17, 4, s46
    ds_read_b128 v[24:27], v120 offset:40960
    ds_read_b128 v[32:35], v120 offset:41472
    ds_read_b128 v[28:31], v120 offset:41024
    ds_read_b128 v[36:39], v120 offset:41536
    v_lshlrev_b32 v121, 2, v16
    ds_read_b32 v48, v121 offset:41984
    ds_read_b32 v49, v121 offset:42048
    ds_read_b32 v50, v121 offset:42112
    ds_read_b32 v51, v121 offset:42176
    s_lshl_b32 s46, s38, 10
    v_add_u32 v120, s46, v18
    s_waitcnt lgkmcnt(0)
    v_pk_mul_f32 v[40:41], v[32:33], s[52:53]
    v_pk_mul_f32 v[42:43], v[34:35], s[52:53]
    v_pk_mul_f32 v[44:45], v[36:37], s[52:53]
    v_pk_mul_f32 v[46:47], v[38:39], s[52:53]
    v_pk_fma_f32 v[88:89], v[24:25], v[48:49], v[88:89] op_sel:[0,1,0] op_sel_hi:[1,1,1] neg_lo:[1,0,0] neg_hi:[1,0,0]
    v_pk_fma_f32 v[90:91], v[26:27], v[48:49], v[90:91] op_sel:[0,1,0] op_sel_hi:[1,1,1] neg_lo:[1,0,0] neg_hi:[1,0,0]
    v_pk_mul_f32 v[88:89], v[88:89], v[32:33]
    v_pk_mul_f32 v[90:91], v[90:91], v[34:35]
    v_cvt_pk_bf16_f32 v68, v88, v89
    v_cvt_pk_bf16_f32 v69, v90, v91
    v_pk_fma_f32 v[92:93], v[28:29], v[48:49], v[92:93] op_sel:[0,1,0] op_sel_hi:[1,1,1] neg_lo:[1,0,0] neg_hi:[1,0,0]
    v_pk_fma_f32 v[94:95], v[30:31], v[48:49], v[94:95] op_sel:[0,1,0] op_sel_hi:[1,1,1] neg_lo:[1,0,0] neg_hi:[1,0,0]
    v_pk_mul_f32 v[92:93], v[92:93], v[36:37]
    v_pk_mul_f32 v[94:95], v[94:95], v[38:39]
    v_cvt_pk_bf16_f32 v70, v92, v93
    v_cvt_pk_bf16_f32 v71, v94, v95
    ds_write_b128 v120, v[68:71] offset:47104
    v_pk_fma_f32 v[104:105], v[24:25], v[50:51], v[104:105] op_sel:[0,1,0] op_sel_hi:[1,1,1] neg_lo:[1,0,0] neg_hi:[1,0,0]
    v_pk_fma_f32 v[106:107], v[26:27], v[50:51], v[106:107] op_sel:[0,1,0] op_sel_hi:[1,1,1] neg_lo:[1,0,0] neg_hi:[1,0,0]
    v_pk_mul_f32 v[104:105], v[104:105], v[32:33]
    v_pk_mul_f32 v[106:107], v[106:107], v[34:35]
    v_cvt_pk_bf16_f32 v76, v104, v105
    v_cvt_pk_bf16_f32 v77, v106, v107
    v_pk_fma_f32 v[108:109], v[28:29], v[50:51], v[108:109] op_sel:[0,1,0] op_sel_hi:[1,1,1] neg_lo:[1,0,0] neg_hi:[1,0,0]
    v_pk_fma_f32 v[110:111], v[30:31], v[50:51], v[110:111] op_sel:[0,1,0] op_sel_hi:[1,1,1] neg_lo:[1,0,0] neg_hi:[1,0,0]
    v_pk_mul_f32 v[108:109], v[108:109], v[36:37]
    v_pk_mul_f32 v[110:111], v[110:111], v[38:39]
    v_cvt_pk_bf16_f32 v78, v108, v109
    v_cvt_pk_bf16_f32 v79, v110, v111
    ds_write_b128 v120, v[76:79] offset:55296
    v_pk_fma_f32 v[80:81], v[24:25], v[48:49], v[80:81] op_sel:[0,0,0] op_sel_hi:[1,0,1] neg_lo:[1,0,0] neg_hi:[1,0,0]
    v_pk_fma_f32 v[82:83], v[26:27], v[48:49], v[82:83] op_sel:[0,0,0] op_sel_hi:[1,0,1] neg_lo:[1,0,0] neg_hi:[1,0,0]
    v_pk_mul_f32 v[56:57], v[80:81], v[40:41] op_sel:[0,0] op_sel_hi:[1,1]
    v_pk_mul_f32 v[58:59], v[82:83], v[42:43] op_sel:[0,0] op_sel_hi:[1,1]
    v_pk_fma_f32 v[80:81], v[80:81], v[32:33], s[50:51] op_sel:[0,0,0] op_sel_hi:[1,1,1]
    v_pk_fma_f32 v[82:83], v[82:83], v[34:35], s[50:51] op_sel:[0,0,0] op_sel_hi:[1,1,1]
    v_exp_f32 v56, v56 clamp
    v_exp_f32 v57, v57 clamp
    v_exp_f32 v58, v58 clamp
    v_exp_f32 v59, v59 clamp
    v_max_f32 v80, s50, v80
    v_max_f32 v81, s50, v81
    v_max_f32 v82, s50, v82
    v_max_f32 v83, s50, v83
    v_pk_add_f32 v[80:81], v[80:81], v[56:57]
    v_pk_add_f32 v[82:83], v[82:83], v[58:59]
    v_cvt_pk_bf16_f32 v64, v80, v81
    v_cvt_pk_bf16_f32 v65, v82, v83
    v_pk_fma_f32 v[84:85], v[28:29], v[48:49], v[84:85] op_sel:[0,0,0] op_sel_hi:[1,0,1] neg_lo:[1,0,0] neg_hi:[1,0,0]
    v_pk_fma_f32 v[86:87], v[30:31], v[48:49], v[86:87] op_sel:[0,0,0] op_sel_hi:[1,0,1] neg_lo:[1,0,0] neg_hi:[1,0,0]
    v_pk_mul_f32 v[60:61], v[84:85], v[44:45] op_sel:[0,0] op_sel_hi:[1,1]
    v_pk_mul_f32 v[62:63], v[86:87], v[46:47] op_sel:[0,0] op_sel_hi:[1,1]
    v_pk_fma_f32 v[84:85], v[84:85], v[36:37], s[50:51] op_sel:[0,0,0] op_sel_hi:[1,1,1]
    v_pk_fma_f32 v[86:87], v[86:87], v[38:39], s[50:51] op_sel:[0,0,0] op_sel_hi:[1,1,1]
    v_exp_f32 v60, v60 clamp
    v_exp_f32 v61, v61 clamp
    v_exp_f32 v62, v62 clamp
    v_exp_f32 v63, v63 clamp
    v_max_f32 v84, s50, v84
    v_max_f32 v85, s50, v85
    v_max_f32 v86, s50, v86
    v_max_f32 v87, s50, v87
    v_pk_add_f32 v[84:85], v[84:85], v[60:61]
    v_pk_add_f32 v[86:87], v[86:87], v[62:63]
    v_cvt_pk_bf16_f32 v66, v84, v85
    v_cvt_pk_bf16_f32 v67, v86, v87
    ds_write_b128 v120, v[64:67] offset:43008
    v_pk_fma_f32 v[96:97], v[24:25], v[50:51], v[96:97] op_sel:[0,0,0] op_sel_hi:[1,0,1] neg_lo:[1,0,0] neg_hi:[1,0,0]
    v_pk_fma_f32 v[98:99], v[26:27], v[50:51], v[98:99] op_sel:[0,0,0] op_sel_hi:[1,0,1] neg_lo:[1,0,0] neg_hi:[1,0,0]
    v_pk_mul_f32 v[56:57], v[96:97], v[40:41] op_sel:[0,0] op_sel_hi:[1,1]
    v_pk_mul_f32 v[58:59], v[98:99], v[42:43] op_sel:[0,0] op_sel_hi:[1,1]
    v_pk_fma_f32 v[96:97], v[96:97], v[32:33], s[50:51] op_sel:[0,0,0] op_sel_hi:[1,1,1]
    v_pk_fma_f32 v[98:99], v[98:99], v[34:35], s[50:51] op_sel:[0,0,0] op_sel_hi:[1,1,1]
    v_exp_f32 v56, v56 clamp
    v_exp_f32 v57, v57 clamp
    v_exp_f32 v58, v58 clamp
    v_exp_f32 v59, v59 clamp
    v_max_f32 v96, s50, v96
    v_max_f32 v97, s50, v97
    v_max_f32 v98, s50, v98
    v_max_f32 v99, s50, v99
    v_pk_add_f32 v[96:97], v[96:97], v[56:57]
    v_pk_add_f32 v[98:99], v[98:99], v[58:59]
    v_cvt_pk_bf16_f32 v72, v96, v97
    v_cvt_pk_bf16_f32 v73, v98, v99
    v_pk_fma_f32 v[100:101], v[28:29], v[50:51], v[100:101] op_sel:[0,0,0] op_sel_hi:[1,0,1] neg_lo:[1,0,0] neg_hi:[1,0,0]
    v_pk_fma_f32 v[102:103], v[30:31], v[50:51], v[102:103] op_sel:[0,0,0] op_sel_hi:[1,0,1] neg_lo:[1,0,0] neg_hi:[1,0,0]
    v_pk_mul_f32 v[60:61], v[100:101], v[44:45] op_sel:[0,0] op_sel_hi:[1,1]
    v_pk_mul_f32 v[62:63], v[102:103], v[46:47] op_sel:[0,0] op_sel_hi:[1,1]
    v_pk_fma_f32 v[100:101], v[100:101], v[36:37], s[50:51] op_sel:[0,0,0] op_sel_hi:[1,1,1]
    v_pk_fma_f32 v[102:103], v[102:103], v[38:39], s[50:51] op_sel:[0,0,0] op_sel_hi:[1,1,1]
    v_exp_f32 v60, v60 clamp
    v_exp_f32 v61, v61 clamp
    v_exp_f32 v62, v62 clamp
    v_exp_f32 v63, v63 clamp
    v_max_f32 v100, s50, v100
    v_max_f32 v101, s50, v101
    v_max_f32 v102, s50, v102
    v_max_f32 v103, s50, v103
    v_pk_add_f32 v[100:101], v[100:101], v[60:61]
    v_pk_add_f32 v[102:103], v[102:103], v[62:63]
    v_cvt_pk_bf16_f32 v74, v100, v101
    v_cvt_pk_bf16_f32 v75, v102, v103
    ds_write_b128 v120, v[72:75] offset:51200
    s_branch L_b2_10
L_q_8:
    s_waitcnt vmcnt(11)
    s_barrier
    v_mfma_f32_16x16x32_bf16 v[104:107], v[20:23], v[32:35], v[104:107]
    ds_read_b128 v[24:27], v6 offset:0
    ds_read_b128 v[28:31], v6 offset:2048
    v_mfma_f32_16x16x32_bf16 v[108:111], v[20:23], v[36:39], v[108:111]
    ds_read_b64_tr_b16 v[40:41], v8 offset:0
    ds_read_b64_tr_b16 v[42:43], v8 offset:3072
    v_mfma_f32_16x16x32_bf16 v[80:83], v[60:63], v[32:35], v[80:83]
    ds_read_b64_tr_b16 v[44:45], v9 offset:0
    ds_read_b64_tr_b16 v[46:47], v9 offset:3072
    v_mfma_f32_16x16x32_bf16 v[84:87], v[60:63], v[36:39], v[84:87]
    ds_read_b64_tr_b16 v[48:49], v10 offset:0
    ds_read_b64_tr_b16 v[50:51], v10 offset:3072
    v_mfma_f32_16x16x32_bf16 v[88:91], v[64:67], v[32:35], v[88:91]
    ds_read_b64_tr_b16 v[52:53], v11 offset:0
    ds_read_b64_tr_b16 v[54:55], v11 offset:3072
    v_mfma_f32_16x16x32_bf16 v[92:95], v[64:67], v[36:39], v[92:95]
    v_mfma_f32_16x16x32_bf16 v[96:99], v[32:35], v[68:71], v[96:99]
    s_add_u32 m0, s45, s41
    s_add_u32 s46, s45, s42
    buffer_load_dwordx4 v1, s[8:11], s39 offen lds
    v_mfma_f32_16x16x32_bf16 v[100:103], v[36:39], v[68:71], v[100:103]
    v_mfma_f32_16x16x32_bf16 v[112:115], v[20:23], v[72:75], v[112:115]
    v_mfma_f32_16x16x32_bf16 v[196:199], v[32:35], v[32:35], v[196:199]
    buffer_load_dwordx4 v2, s[8:11], s39 offen offset:1024 lds
    s_mov_b32 m0, s46
    s_add_u32 s39, s39, 128
    v_mfma_f32_16x16x32_bf16 v[200:203], v[36:39], v[36:39], v[200:203]
    s_waitcnt lgkmcnt(0)
    v_mfma_f32_16x16x32_bf16 v[104:107], v[20:23], v[24:27], v[104:107]
    ds_read_b128 v[32:35], v7 offset:0
    ds_read_b128 v[36:39], v7 offset:2048
    v_mfma_f32_16x16x32_bf16 v[108:111], v[20:23], v[28:31], v[108:111]
    ds_read_b64_tr_b16 v[60:61], v8 offset:12288
    ds_read_b64_tr_b16 v[62:63], v8 offset:15360
    v_mfma_f32_16x16x32_bf16 v[80:83], v[40:43], v[24:27], v[80:83]
    ds_read_b64_tr_b16 v[64:65], v9 offset:12288
    ds_read_b64_tr_b16 v[66:67], v9 offset:15360
    v_mfma_f32_16x16x32_bf16 v[84:87], v[40:43], v[28:31], v[84:87]
    ds_read_b64_tr_b16 v[68:69], v10 offset:12288
    ds_read_b64_tr_b16 v[70:71], v10 offset:15360
    v_mfma_f32_16x16x32_bf16 v[88:91], v[44:47], v[24:27], v[88:91]
    ds_read_b64_tr_b16 v[72:73], v11 offset:12288
    ds_read_b64_tr_b16 v[74:75], v11 offset:15360
    v_mfma_f32_16x16x32_bf16 v[92:95], v[44:47], v[28:31], v[92:95]
    buffer_load_dwordx4 v3, s[12:15], s40 offen lds
    v_mfma_f32_16x16x32_bf16 v[96:99], v[24:27], v[48:51], v[96:99]
    v_mfma_f32_16x16x32_bf16 v[100:103], v[28:31], v[48:51], v[100:103]
    buffer_load_dwordx4 v4, s[12:15], s40 offen offset:1024 lds
    v_mfma_f32_16x16x32_bf16 v[112:115], v[20:23], v[52:55], v[112:115]
    v_mfma_f32_16x16x32_bf16 v[196:199], v[24:27], v[24:27], v[196:199]
    buffer_load_dwordx4 v5, s[12:15], s40 offen offset:2048 lds
    s_add_u32 s40, s40, 221184
    s_add_u32 s45, s45, 40960
    s_cmp_eq_u32 s45, 163840
    s_cselect_b32 s45, 0, s45
    v_mfma_f32_16x16x32_bf16 v[200:203], v[28:31], v[28:31], v[200:203]
    v_add_u32 v6, 40960, v6
    v_add_u32 v7, 40960, v7
    v_add_u32 v8, 40960, v8
    v_add_u32 v9, 40960, v9
    v_add_u32 v11, 40960, v11
    v_add_u32 v10, 40960, v10
    s_mov_b32 s43, 1
L_slot_13:
    s_cmp_eq_u32 s43, 3
    s_mov_b32 s44, 40960
    s_cselect_b32 s44, 4294844416, s44
    s_add_u32 s43, s43, 1
    s_waitcnt vmcnt(10) lgkmcnt(0)
    s_barrier
    v_mfma_f32_16x16x32_bf16 v[104:107], v[20:23], v[32:35], v[104:107]
    ds_read_b128 v[24:27], v6 offset:0
    ds_read_b128 v[28:31], v6 offset:2048
    v_mfma_f32_16x16x32_bf16 v[108:111], v[20:23], v[36:39], v[108:111]
    ds_read_b64_tr_b16 v[40:41], v8 offset:0
    ds_read_b64_tr_b16 v[42:43], v8 offset:3072
    v_mfma_f32_16x16x32_bf16 v[80:83], v[60:63], v[32:35], v[80:83]
    ds_read_b64_tr_b16 v[44:45], v9 offset:0
    ds_read_b64_tr_b16 v[46:47], v9 offset:3072
    v_mfma_f32_16x16x32_bf16 v[84:87], v[60:63], v[36:39], v[84:87]
    ds_read_b64_tr_b16 v[48:49], v10 offset:0
    ds_read_b64_tr_b16 v[50:51], v10 offset:3072
    v_mfma_f32_16x16x32_bf16 v[88:91], v[64:67], v[32:35], v[88:91]
    ds_read_b64_tr_b16 v[52:53], v11 offset:0
    ds_read_b64_tr_b16 v[54:55], v11 offset:3072
    v_mfma_f32_16x16x32_bf16 v[92:95], v[64:67], v[36:39], v[92:95]
    v_mfma_f32_16x16x32_bf16 v[96:99], v[32:35], v[68:71], v[96:99]
    s_add_u32 m0, s45, s41
    s_add_u32 s46, s45, s42
    buffer_load_dwordx4 v1, s[8:11], s39 offen lds
    v_mfma_f32_16x16x32_bf16 v[100:103], v[36:39], v[68:71], v[100:103]
    v_mfma_f32_16x16x32_bf16 v[112:115], v[20:23], v[72:75], v[112:115]
    v_mfma_f32_16x16x32_bf16 v[196:199], v[32:35], v[32:35], v[196:199]
    buffer_load_dwordx4 v2, s[8:11], s39 offen offset:1024 lds
    s_mov_b32 m0, s46
    s_add_u32 s39, s39, 128
    v_mfma_f32_16x16x32_bf16 v[200:203], v[36:39], v[36:39], v[200:203]
    s_waitcnt lgkmcnt(0)
    v_mfma_f32_16x16x32_bf16 v[104:107], v[20:23], v[24:27], v[104:107]
    ds_read_b128 v[32:35], v7 offset:0
    ds_read_b128 v[36:39], v7 offset:2048
    v_mfma_f32_16x16x32_bf16 v[108:111], v[20:23], v[28:31], v[108:111]
    ds_read_b64_tr_b16 v[60:61], v8 offset:12288
    ds_read_b64_tr_b16 v[62:63], v8 offset:15360
    v_mfma_f32_16x16x32_bf16 v[80:83], v[40:43], v[24:27], v[80:83]
    ds_read_b64_tr_b16 v[64:65], v9 offset:12288
    ds_read_b64_tr_b16 v[66:67], v9 offset:15360
    v_mfma_f32_16x16x32_bf16 v[84:87], v[40:43], v[28:31], v[84:87]
    ds_read_b64_tr_b16 v[68:69], v10 offset:12288
    ds_read_b64_tr_b16 v[70:71], v10 offset:15360
    v_mfma_f32_16x16x32_bf16 v[88:91], v[44:47], v[24:27], v[88:91]
    ds_read_b64_tr_b16 v[72:73], v11 offset:12288
    ds_read_b64_tr_b16 v[74:75], v11 offset:15360
    v_mfma_f32_16x16x32_bf16 v[92:95], v[44:47], v[28:31], v[92:95]
    buffer_load_dwordx4 v3, s[12:15], s40 offen lds
    v_mfma_f32_16x16x32_bf16 v[96:99], v[24:27], v[48:51], v[96:99]
    v_mfma_f32_16x16x32_bf16 v[100:103], v[28:31], v[48:51], v[100:103]
    buffer_load_dwordx4 v4, s[12:15], s40 offen offset:1024 lds
    v_mfma_f32_16x16x32_bf16 v[112:115], v[20:23], v[52:55], v[112:115]
    v_mfma_f32_16x16x32_bf16 v[196:199], v[24:27], v[24:27], v[196:199]
    buffer_load_dwordx4 v5, s[12:15], s40 offen offset:2048 lds
    s_add_u32 s40, s40, 221184
    s_add_u32 s45, s45, 40960
    s_cmp_eq_u32 s45, 163840
    s_cselect_b32 s45, 0, s45
    v_mfma_f32_16x16x32_bf16 v[200:203], v[28:31], v[28:31], v[200:203]
    v_add_u32 v6, s44, v6
    v_add_u32 v7, s44, v7
    v_add_u32 v8, s44, v8
    v_add_u32 v9, s44, v9
    v_add_u32 v11, s44, v11
    v_add_u32 v10, s44, v10
    s_cmp_lt_u32 s43, 6
    s_cbranch_scc1 L_slot_13
    s_waitcnt vmcnt(10) lgkmcnt(0)
    buffer_load_ubyte v19, v16, s[24:27], 0 offen sc1
    s_barrier
    v_mfma_f32_16x16x32_bf16 v[104:107], v[20:23], v[32:35], v[104:107]
    ds_read_b128 v[24:27], v6 offset:0
    ds_read_b128 v[28:31], v6 offset:2048
    v_mfma_f32_16x16x32_bf16 v[108:111], v[20:23], v[36:39], v[108:111]
    ds_read_b64_tr_b16 v[40:41], v8 offset:0
    ds_read_b64_tr_b16 v[42:43], v8 offset:3072
    v_mfma_f32_16x16x32_bf16 v[80:83], v[60:63], v[32:35], v[80:83]
    ds_read_b64_tr_b16 v[44:45], v9 offset:0
    ds_read_b64_tr_b16 v[46:47], v9 offset:3072
    v_mfma_f32_16x16x32_bf16 v[84:87], v[60:63], v[36:39], v[84:87]
    ds_read_b64_tr_b16 v[48:49], v10 offset:0
    ds_read_b64_tr_b16 v[50:51], v10 offset:3072
    v_mfma_f32_16x16x32_bf16 v[88:91], v[64:67], v[32:35], v[88:91]
    ds_read_b64_tr_b16 v[52:53], v11 offset:0
    ds_read_b64_tr_b16 v[54:55], v11 offset:3072
    v_mfma_f32_16x16x32_bf16 v[92:95], v[64:67], v[36:39], v[92:95]
    v_mfma_f32_16x16x32_bf16 v[96:99], v[32:35], v[68:71], v[96:99]
    s_add_u32 m0, s62, 65536
    s_nop 0
    buffer_load_dwordx4 v204, s[28:31], s55 offen lds
    v_mfma_f32_16x16x32_bf16 v[100:103], v[36:39], v[68:71], v[100:103]
    v_mfma_f32_16x16x32_bf16 v[112:115], v[20:23], v[72:75], v[112:115]
    v_mfma_f32_16x16x32_bf16 v[196:199], v[32:35], v[32:35], v[196:199]
    s_add_u32 m0, s62, 73728
    s_nop 0
    buffer_load_dwordx4 v205, s[28:31], s55 offen lds
    v_mfma_f32_16x16x32_bf16 v[200:203], v[36:39], v[36:39], v[200:203]
    s_waitcnt lgkmcnt(0)
    v_mfma_f32_16x16x32_bf16 v[104:107], v[20:23], v[24:27], v[104:107]
    ds_read_b128 v[32:35], v7 offset:0
    ds_read_b128 v[36:39], v7 offset:2048
    v_mfma_f32_16x16x32_bf16 v[108:111], v[20:23], v[28:31], v[108:111]
    ds_read_b64_tr_b16 v[60:61], v8 offset:12288
    ds_read_b64_tr_b16 v[62:63], v8 offset:15360
    v_mfma_f32_16x16x32_bf16 v[80:83], v[40:43], v[24:27], v[80:83]
    ds_read_b64_tr_b16 v[64:65], v9 offset:12288
    ds_read_b64_tr_b16 v[66:67], v9 offset:15360
    v_mfma_f32_16x16x32_bf16 v[84:87], v[40:43], v[28:31], v[84:87]
    ds_read_b64_tr_b16 v[68:69], v10 offset:12288
    ds_read_b64_tr_b16 v[70:71], v10 offset:15360
    v_mfma_f32_16x16x32_bf16 v[88:91], v[44:47], v[24:27], v[88:91]
    ds_read_b64_tr_b16 v[72:73], v11 offset:12288
    ds_read_b64_tr_b16 v[74:75], v11 offset:15360
    v_mfma_f32_16x16x32_bf16 v[92:95], v[44:47], v[28:31], v[92:95]
    v_mfma_f32_16x16x32_bf16 v[96:99], v[24:27], v[48:51], v[96:99]
    v_mfma_f32_16x16x32_bf16 v[100:103], v[28:31], v[48:51], v[100:103]
    v_mfma_f32_16x16x32_bf16 v[112:115], v[20:23], v[52:55], v[112:115]
    v_mfma_f32_16x16x32_bf16 v[196:199], v[24:27], v[24:27], v[196:199]
    v_mfma_f32_16x16x32_bf16 v[200:203], v[28:31], v[28:31], v[200:203]
    v_add_u32 v6, 40960, v6
    v_add_u32 v7, 40960, v7
    v_add_u32 v8, 40960, v8
    v_add_u32 v9, 40960, v9
    v_add_u32 v11, 40960, v11
    v_add_u32 v10, 40960, v10
    s_waitcnt vmcnt(8) lgkmcnt(0)
    s_barrier
    v_mfma_f32_16x16x32_bf16 v[104:107], v[20:23], v[32:35], v[104:107]
    ds_read_b128 v[24:27], v6 offset:0
    ds_read_b128 v[28:31], v6 offset:2048
    v_mfma_f32_16x16x32_bf16 v[108:111], v[20:23], v[36:39], v[108:111]
    ds_read_b64_tr_b16 v[40:41], v8 offset:0
    ds_read_b64_tr_b16 v[42:43], v8 offset:3072
    v_mfma_f32_16x16x32_bf16 v[80:83], v[60:63], v[32:35], v[80:83]
    ds_read_b64_tr_b16 v[44:45], v9 offset:0
    ds_read_b64_tr_b16 v[46:47], v9 offset:3072
    v_mfma_f32_16x16x32_bf16 v[84:87], v[60:63], v[36:39], v[84:87]
    ds_read_b64_tr_b16 v[48:49], v10 offset:0
    ds_read_b64_tr_b16 v[50:51], v10 offset:3072
    v_mfma_f32_16x16x32_bf16 v[88:91], v[64:67], v[32:35], v[88:91]
    ds_read_b64_tr_b16 v[52:53], v11 offset:0
    ds_read_b64_tr_b16 v[54:55], v11 offset:3072
    v_mfma_f32_16x16x32_bf16 v[92:95], v[64:67], v[36:39], v[92:95]
    v_mfma_f32_16x16x32_bf16 v[96:99], v[32:35], v[68:71], v[96:99]
    s_add_u32 m0, s62, 81920
    s_nop 0
    buffer_load_dwordx4 v206, s[28:31], s55 offen lds
    v_mfma_f32_16x16x32_bf16 v[100:103], v[36:39], v[68:71], v[100:103]
    v_mfma_f32_16x16x32_bf16 v[112:115], v[20:23], v[72:75], v[112:115]
    v_mfma_f32_16x16x32_bf16 v[196:199], v[32:35], v[32:35], v[196:199]
    s_add_u32 m0, s62, 90112
    s_nop 0
    buffer_load_dwordx4 v207, s[28:31], s55 offen lds
    v_mfma_f32_16x16x32_bf16 v[200:203], v[36:39], v[36:39], v[200:203]
    s_waitcnt lgkmcnt(0)
    v_mfma_f32_16x16x32_bf16 v[104:107], v[20:23], v[24:27], v[104:107]
    ds_read_b128 v[32:35], v7 offset:0
    ds_read_b128 v[36:39], v7 offset:2048
    v_mfma_f32_16x16x32_bf16 v[108:111], v[20:23], v[28:31], v[108:111]
    ds_read_b64_tr_b16 v[60:61], v8 offset:12288
    ds_read_b64_tr_b16 v[62:63], v8 offset:15360
    v_mfma_f32_16x16x32_bf16 v[80:83], v[40:43], v[24:27], v[80:83]
    ds_read_b64_tr_b16 v[64:65], v9 offset:12288
    ds_read_b64_tr_b16 v[66:67], v9 offset:15360
    v_mfma_f32_16x16x32_bf16 v[84:87], v[40:43], v[28:31], v[84:87]
    ds_read_b64_tr_b16 v[68:69], v10 offset:12288
    ds_read_b64_tr_b16 v[70:71], v10 offset:15360
    v_mfma_f32_16x16x32_bf16 v[88:91], v[44:47], v[24:27], v[88:91]
    ds_read_b64_tr_b16 v[72:73], v11 offset:12288
    ds_read_b64_tr_b16 v[74:75], v11 offset:15360
    v_mfma_f32_16x16x32_bf16 v[92:95], v[44:47], v[28:31], v[92:95]
    s_add_u32 m0, s62, 98304
    s_nop 0
    buffer_load_dwordx4 v208, s[28:31], s55 offen lds
    v_mfma_f32_16x16x32_bf16 v[96:99], v[24:27], v[48:51], v[96:99]
    v_mfma_f32_16x16x32_bf16 v[100:103], v[28:31], v[48:51], v[100:103]
    s_add_u32 m0, s62, 106496
    s_add_u32 s55, s55, 294912
    buffer_load_dwordx4 v204, s[28:31], s55 offen lds
    v_mfma_f32_16x16x32_bf16 v[112:115], v[20:23], v[52:55], v[112:115]
    v_mfma_f32_16x16x32_bf16 v[196:199], v[24:27], v[24:27], v[196:199]
    s_add_u32 m0, s62, 114688
    s_nop 0
    buffer_load_dwordx4 v205, s[28:31], s55 offen lds
    v_mfma_f32_16x16x32_bf16 v[200:203], v[28:31], v[28:31], v[200:203]
    v_add_u32 v6, 4294844416, v6
    v_add_u32 v7, 4294844416, v7
    v_add_u32 v8, 4294844416, v8
    v_add_u32 v9, 4294844416, v9
    v_add_u32 v11, 4294844416, v11
    v_add_u32 v10, 4294844416, v10
    s_waitcnt vmcnt(8) lgkmcnt(0)
    s_barrier
    v_mfma_f32_16x16x32_bf16 v[104:107], v[20:23], v[32:35], v[104:107]
    ds_read_b128 v[24:27], v6 offset:0
    ds_read_b128 v[28:31], v6 offset:2048
    v_mfma_f32_16x16x32_bf16 v[108:111], v[20:23], v[36:39], v[108:111]
    ds_read_b64_tr_b16 v[40:41], v8 offset:0
    ds_read_b64_tr_b16 v[42:43], v8 offset:3072
    v_mfma_f32_16x16x32_bf16 v[80:83], v[60:63], v[32:35], v[80:83]
    ds_read_b64_tr_b16 v[44:45], v9 offset:0
    ds_read_b64_tr_b16 v[46:47], v9 offset:3072
    v_mfma_f32_16x16x32_bf16 v[84:87], v[60:63], v[36:39], v[84:87]
    ds_read_b64_tr_b16 v[48:49], v10 offset:0
    ds_read_b64_tr_b16 v[50:51], v10 offset:3072
    v_mfma_f32_16x16x32_bf16 v[88:91], v[64:67], v[32:35], v[88:91]
    ds_read_b64_tr_b16 v[52:53], v11 offset:0
    ds_read_b64_tr_b16 v[54:55], v11 offset:3072
    v_mfma_f32_16x16x32_bf16 v[92:95], v[64:67], v[36:39], v[92:95]
    v_mfma_f32_16x16x32_bf16 v[96:99], v[32:35], v[68:71], v[96:99]
    s_add_u32 m0, s62, 122880
    s_nop 0
    buffer_load_dwordx4 v206, s[28:31], s55 offen lds
    v_mfma_f32_16x16x32_bf16 v[100:103], v[36:39], v[68:71], v[100:103]
    v_mfma_f32_16x16x32_bf16 v[112:115], v[20:23], v[72:75], v[112:115]
    v_mfma_f32_16x16x32_bf16 v[196:199], v[32:35], v[32:35], v[196:199]
    s_add_u32 m0, s62, 131072
    s_nop 0
    buffer_load_dwordx4 v207, s[28:31], s55 offen lds
    v_mfma_f32_16x16x32_bf16 v[200:203], v[36:39], v[36:39], v[200:203]
    s_waitcnt lgkmcnt(0)
    v_mfma_f32_16x16x32_bf16 v[104:107], v[20:23], v[24:27], v[104:107]
    ds_read_b128 v[32:35], v7 offset:0
    ds_read_b128 v[36:39], v7 offset:2048
    v_mfma_f32_16x16x32_bf16 v[108:111], v[20:23], v[28:31], v[108:111]
    ds_read_b64_tr_b16 v[60:61], v8 offset:12288
    ds_read_b64_tr_b16 v[62:63], v8 offset:15360
    v_mfma_f32_16x16x32_bf16 v[80:83], v[40:43], v[24:27], v[80:83]
    ds_read_b64_tr_b16 v[64:65], v9 offset:12288
    ds_read_b64_tr_b16 v[66:67], v9 offset:15360
    v_mfma_f32_16x16x32_bf16 v[84:87], v[40:43], v[28:31], v[84:87]
    ds_read_b64_tr_b16 v[68:69], v10 offset:12288
    ds_read_b64_tr_b16 v[70:71], v10 offset:15360
    v_mfma_f32_16x16x32_bf16 v[88:91], v[44:47], v[24:27], v[88:91]
    ds_read_b64_tr_b16 v[72:73], v11 offset:12288
    ds_read_b64_tr_b16 v[74:75], v11 offset:15360
    v_mfma_f32_16x16x32_bf16 v[92:95], v[44:47], v[28:31], v[92:95]
    s_add_u32 m0, s62, 139264
    s_nop 0
    buffer_load_dwordx4 v208, s[28:31], s55 offen lds
    v_mfma_f32_16x16x32_bf16 v[96:99], v[24:27], v[48:51], v[96:99]
    v_mfma_f32_16x16x32_bf16 v[100:103], v[28:31], v[48:51], v[100:103]
    s_add_u32 m0, s62, 147456
    s_add_u32 s55, s55, 294912
    buffer_load_dwordx4 v204, s[28:31], s55 offen lds
    v_mfma_f32_16x16x32_bf16 v[112:115], v[20:23], v[52:55], v[112:115]
    v_mfma_f32_16x16x32_bf16 v[196:199], v[24:27], v[24:27], v[196:199]
    s_cmp_ge_u32 s38, 2
    s_cbranch_scc1 L_w11_14
    s_add_u32 m0, s62, 155648
    s_nop 0
    buffer_load_dwordx4 v205, s[28:31], s55 offen lds
    L_w11_14:
    v_mfma_f32_16x16x32_bf16 v[200:203], v[28:31], v[28:31], v[200:203]
    s_waitcnt vmcnt(11)
    s_lshl_b32 s46, s2, 3
    s_add_u32 s46, s46, s38
    s_mul_i32 s46, s46, 2592
    s_mov_b64 exec, 0x1fffff
    buffer_load_dword v117, v116, s[64:67], s46 offen
    s_mov_b64 exec, -1
    s_waitcnt lgkmcnt(0)
    v_mfma_f32_16x16x32_bf16 v[104:107], v[20:23], v[32:35], v[104:107]
    v_mfma_f32_16x16x32_bf16 v[108:111], v[20:23], v[36:39], v[108:111]
    v_mfma_f32_16x16x32_bf16 v[80:83], v[60:63], v[32:35], v[80:83]
    v_mfma_f32_16x16x32_bf16 v[84:87], v[60:63], v[36:39], v[84:87]
    v_mfma_f32_16x16x32_bf16 v[88:91], v[64:67], v[32:35], v[88:91]
    v_mfma_f32_16x16x32_bf16 v[92:95], v[64:67], v[36:39], v[92:95]
    v_mfma_f32_16x16x32_bf16 v[96:99], v[32:35], v[68:71], v[96:99]
    v_mfma_f32_16x16x32_bf16 v[100:103], v[36:39], v[68:71], v[100:103]
    v_mfma_f32_16x16x32_bf16 v[112:115], v[20:23], v[72:75], v[112:115]
    v_mfma_f32_16x16x32_bf16 v[196:199], v[32:35], v[32:35], v[196:199]
    v_mfma_f32_16x16x32_bf16 v[200:203], v[36:39], v[36:39], v[200:203]
    s_lshl_b32 s46, s38, 6
    v_lshl_add_u32 v120, v16, 2, s46
    s_nop 6
    ds_write_b32 v120, v112 offset:41984
    s_mov_b32 vcc_lo, 0xaaaaaaaa
    s_mov_b32 vcc_hi, vcc_lo
    s_mov_b32 s48, 0xcccccccc
    s_mov_b32 s49, s48
    v_cndmask_b32 v196, v196, v197, vcc
    v_cndmask_b32 v198, v198, v199, vcc
    v_mul_f32 v124, 0x3ae38e39, v104
    v_cndmask_b32 v196, v196, v198, s[48:49]
    v_mov_b32 v126, 0x3727c5ac
    v_fmac_f32 v126, 0x3ae38e39, v196
    v_fma_f32 v126, -v124, v124, v126
    v_max_f32 v126, 0x3727c5ac, v126
    v_rsq_f32 v126, v126
    v_cndmask_b32 v200, v200, v201, vcc
    v_cndmask_b32 v202, v202, v203, vcc
    v_mul_f32 v125, 0x3ae38e39, v108
    v_cndmask_b32 v200, v200, v202, s[48:49]
    v_mov_b32 v127, 0x3727c5ac
    v_fmac_f32 v127, 0x3ae38e39, v200
    v_fma_f32 v127, -v125, v125, v127
    v_max_f32 v127, 0x3727c5ac, v127
    v_rsq_f32 v127, v127
    s_and_b32 s46, s38, 3
    s_lshl_b32 s46, s46, 7
    v_lshl_add_u32 v120, v16, 2, s46
    s_mov_b32 exec_lo, 0x00f0000f
    s_mov_b32 exec_hi, 0xf0000f00
    ds_write_b32 v120, v124 offset:40960
    ds_write_b32 v120, v126 offset:41472
    ds_write_b32 v120, v125 offset:41024
    ds_write_b32 v120, v127 offset:41536
    s_mov_b64 exec, -1
    ds_read_b32 v126, v120 offset:41472
    ds_read_b32 v127, v120 offset:41536
    s_waitcnt lgkmcnt(0)
    s_barrier
    v_pk_mul_f32 v[128:129], v[126:127], s[52:53]
    s_cmp_lg_u32 s37, 0
    s_cbranch_scc1 L_nomu_15
    s_lshl_b32 s47, s36, 9
    s_add_u32 s47, s47, 23642112
    s_mov_b64 exec, 0xffff
    buffer_store_dword v124, v120, s[16:19], s47 offen offset:0 sc1
    buffer_store_dword v125, v120, s[16:19], s47 offen offset:64 sc1
    s_mov_b64 exec, -1
L_nomu_15:
    s_and_b32 s46, s38, 3
    s_lshl_b32 s46, s46, 7
    v_lshl_add_u32 v120, v17, 4, s46
    ds_read_b128 v[24:27], v120 offset:40960
    ds_read_b128 v[32:35], v120 offset:41472
    ds_read_b128 v[28:31], v120 offset:41024
    ds_read_b128 v[36:39], v120 offset:41536
    v_lshlrev_b32 v121, 2, v16
    ds_read_b32 v130, v121 offset:42368
    v_lshlrev_b32 v121, 4, v17
    ds_read_b128 v[48:51], v121 offset:42240
    ds_read_b128 v[52:55], v121 offset:42304
    s_and_b32 s46, s38, 3
    s_lshl_b32 s46, s46, 10
    v_add_u32 v120, s46, v18
    v_cmp_gt_u32 vcc, 8, v16
    v_cmp_eq_u32 s[40:41], 12, v16
    s_waitcnt lgkmcnt(2)
    v_pk_mul_f32 v[40:41], v[32:33], s[52:53]
    v_pk_mul_f32 v[42:43], v[34:35], s[52:53]
    v_pk_mul_f32 v[44:45], v[36:37], s[52:53]
    v_pk_mul_f32 v[46:47], v[38:39], s[52:53]
    v_pk_fma_f32 v[96:97], v[24:25], v[130:131], v[96:97] op_sel:[0,0,0] op_sel_hi:[1,0,1] neg_lo:[1,0,0] neg_hi:[1,0,0]
    v_pk_fma_f32 v[98:99], v[26:27], v[130:131], v[98:99] op_sel:[0,0,0] op_sel_hi:[1,0,1] neg_lo:[1,0,0] neg_hi:[1,0,0]
    v_pk_mul_f32 v[72:73], v[96:97], v[32:33]
    v_pk_mul_f32 v[74:75], v[98:99], v[34:35]
    v_pk_mul_f32 v[56:57], v[96:97], v[40:41] op_sel:[0,0] op_sel_hi:[1,1]
    v_pk_mul_f32 v[58:59], v[98:99], v[42:43] op_sel:[0,0] op_sel_hi:[1,1]
    v_pk_fma_f32 v[96:97], v[96:97], v[32:33], s[50:51] op_sel:[0,0,0] op_sel_hi:[1,1,1]
    v_pk_fma_f32 v[98:99], v[98:99], v[34:35], s[50:51] op_sel:[0,0,0] op_sel_hi:[1,1,1]
    v_exp_f32 v56, v56 clamp
    v_exp_f32 v57, v57 clamp
    v_exp_f32 v58, v58 clamp
    v_exp_f32 v59, v59 clamp
    v_max_f32 v96, s50, v96
    v_max_f32 v97, s50, v97
    v_max_f32 v98, s50, v98
    v_max_f32 v99, s50, v99
    v_pk_add_f32 v[96:97], v[96:97], v[56:57]
    v_pk_add_f32 v[98:99], v[98:99], v[58:59]
    v_cndmask_b32 v96, v72, v96, vcc
    v_cndmask_b32 v97, v73, v97, vcc
    v_cndmask_b32 v98, v74, v98, vcc
    v_cndmask_b32 v99, v75, v99, vcc
    v_cvt_pk_bf16_f32 v64, v96, v97
    v_cvt_pk_bf16_f32 v65, v98, v99
    v_pk_fma_f32 v[100:101], v[28:29], v[130:131], v[100:101] op_sel:[0,0,0] op_sel_hi:[1,0,1] neg_lo:[1,0,0] neg_hi:[1,0,0]
    v_pk_fma_f32 v[102:103], v[30:31], v[130:131], v[102:103] op_sel:[0,0,0] op_sel_hi:[1,0,1] neg_lo:[1,0,0] neg_hi:[1,0,0]
    v_pk_mul_f32 v[72:73], v[100:101], v[36:37]
    v_pk_mul_f32 v[74:75], v[102:103], v[38:39]
    v_pk_mul_f32 v[56:57], v[100:101], v[44:45] op_sel:[0,0] op_sel_hi:[1,1]
    v_pk_mul_f32 v[58:59], v[102:103], v[46:47] op_sel:[0,0] op_sel_hi:[1,1]
    v_pk_fma_f32 v[100:101], v[100:101], v[36:37], s[50:51] op_sel:[0,0,0] op_sel_hi:[1,1,1]
    v_pk_fma_f32 v[102:103], v[102:103], v[38:39], s[50:51] op_sel:[0,0,0] op_sel_hi:[1,1,1]
    v_exp_f32 v56, v56 clamp
    v_exp_f32 v57, v57 clamp
    v_exp_f32 v58, v58 clamp
    v_exp_f32 v59, v59 clamp
    v_max_f32 v100, s50, v100
    v_max_f32 v101, s50, v101
    v_max_f32 v102, s50, v102
    v_max_f32 v103, s50, v103
    v_pk_add_f32 v[100:101], v[100:101], v[56:57]
    v_pk_add_f32 v[102:103], v[102:103], v[58:59]
    v_cndmask_b32 v100, v72, v100, vcc
    v_cndmask_b32 v101, v73, v101, vcc
    v_cndmask_b32 v102, v74, v102, vcc
    v_cndmask_b32 v103, v75, v103, vcc
    v_cvt_pk_bf16_f32 v66, v100, v101
    v_cvt_pk_bf16_f32 v67, v102, v103
    v_cndmask_b32 v64, v64, v20, s[40:41]
    v_cndmask_b32 v65, v65, v20, s[40:41]
    v_cndmask_b32 v66, v66, v20, s[40:41]
    v_cndmask_b32 v67, v67, v20, s[40:41]
    ds_write_b128 v120, v[64:67] offset:59392
    s_bfe_u32 s46, s38, 0x10001
    s_lshl_b32 s47, s36, 1
    s_add_u32 s46, s46, s47
    s_lshl_b32 s46, s46, 4
    s_add_u32 s46, s46, s37
    s_lshl_b32 s46, s46, 1
    s_and_b32 s47, s38, 1
    s_add_u32 s46, s46, s47
    s_lshl_b32 s46, s46, 11
    s_add_u32 s46, s46, 21233664
    s_waitcnt lgkmcnt(1)
    v_pk_fma_f32 v[80:81], v[48:49], v[124:125], v[80:81] op_sel:[0,0,0] op_sel_hi:[1,0,1] neg_lo:[1,0,0] neg_hi:[1,0,0]
    v_pk_fma_f32 v[82:83], v[50:51], v[124:125], v[82:83] op_sel:[0,0,0] op_sel_hi:[1,0,1] neg_lo:[1,0,0] neg_hi:[1,0,0]
    v_pk_mul_f32 v[56:57], v[80:81], v[128:129] op_sel:[0,0] op_sel_hi:[1,0]
    v_pk_mul_f32 v[58:59], v[82:83], v[128:129] op_sel:[0,0] op_sel_hi:[1,0]
    v_pk_fma_f32 v[80:81], v[80:81], v[126:127], s[50:51] op_sel:[0,0,0] op_sel_hi:[1,0,1]
    v_pk_fma_f32 v[82:83], v[82:83], v[126:127], s[50:51] op_sel:[0,0,0] op_sel_hi:[1,0,1]
    v_exp_f32 v56, v56 clamp
    v_exp_f32 v57, v57 clamp
    v_exp_f32 v58, v58 clamp
    v_exp_f32 v59, v59 clamp
    v_max_f32 v80, s50, v80
    v_max_f32 v81, s50, v81
    v_max_f32 v82, s50, v82
    v_max_f32 v83, s50, v83
    v_pk_add_f32 v[80:81], v[80:81], v[56:57]
    v_pk_add_f32 v[82:83], v[82:83], v[58:59]
    v_cvt_pk_bf16_f32 v68, v80, v81
    v_cvt_pk_bf16_f32 v69, v82, v83
    v_pk_fma_f32 v[88:89], v[52:53], v[124:125], v[88:89] op_sel:[0,0,0] op_sel_hi:[1,0,1] neg_lo:[1,0,0] neg_hi:[1,0,0]
    v_pk_fma_f32 v[90:91], v[54:55], v[124:125], v[90:91] op_sel:[0,0,0] op_sel_hi:[1,0,1] neg_lo:[1,0,0] neg_hi:[1,0,0]
    v_pk_mul_f32 v[60:61], v[88:89], v[128:129] op_sel:[0,0] op_sel_hi:[1,0]
    v_pk_mul_f32 v[62:63], v[90:91], v[128:129] op_sel:[0,0] op_sel_hi:[1,0]
    v_pk_fma_f32 v[88:89], v[88:89], v[126:127], s[50:51] op_sel:[0,0,0] op_sel_hi:[1,0,1]
    v_pk_fma_f32 v[90:91], v[90:91], v[126:127], s[50:51] op_sel:[0,0,0] op_sel_hi:[1,0,1]
    v_exp_f32 v60, v60 clamp
    v_exp_f32 v61, v61 clamp
    v_exp_f32 v62, v62 clamp
    v_exp_f32 v63, v63 clamp
    v_max_f32 v88, s50, v88
    v_max_f32 v89, s50, v89
    v_max_f32 v90, s50, v90
    v_max_f32 v91, s50, v91
    v_pk_add_f32 v[88:89], v[88:89], v[60:61]
    v_pk_add_f32 v[90:91], v[90:91], v[62:63]
    v_cvt_pk_bf16_f32 v70, v88, v89
    v_cvt_pk_bf16_f32 v71, v90, v91
    buffer_store_dwordx4 v[68:71], v18, s[16:19], s46 offen offset:0 sc1
    v_pk_fma_f32 v[84:85], v[48:49], v[124:125], v[84:85] op_sel:[0,1,0] op_sel_hi:[1,1,1] neg_lo:[1,0,0] neg_hi:[1,0,0]
    v_pk_fma_f32 v[86:87], v[50:51], v[124:125], v[86:87] op_sel:[0,1,0] op_sel_hi:[1,1,1] neg_lo:[1,0,0] neg_hi:[1,0,0]
    v_pk_mul_f32 v[56:57], v[84:85], v[128:129] op_sel:[0,1] op_sel_hi:[1,1]
    v_pk_mul_f32 v[58:59], v[86:87], v[128:129] op_sel:[0,1] op_sel_hi:[1,1]
    v_pk_fma_f32 v[84:85], v[84:85], v[126:127], s[50:51] op_sel:[0,1,0] op_sel_hi:[1,1,1]
    v_pk_fma_f32 v[86:87], v[86:87], v[126:127], s[50:51] op_sel:[0,1,0] op_sel_hi:[1,1,1]
    v_exp_f32 v56, v56 clamp
    v_exp_f32 v57, v57 clamp
    v_exp_f32 v58, v58 clamp
    v_exp_f32 v59, v59 clamp
    v_max_f32 v84, s50, v84
    v_max_f32 v85, s50, v85
    v_max_f32 v86, s50, v86
    v_max_f32 v87, s50, v87
    v_pk_add_f32 v[84:85], v[84:85], v[56:57]
    v_pk_add_f32 v[86:87], v[86:87], v[58:59]
    v_cvt_pk_bf16_f32 v72, v84, v85
    v_cvt_pk_bf16_f32 v73, v86, v87
    v_pk_fma_f32 v[92:93], v[52:53], v[124:125], v[92:93] op_sel:[0,1,0] op_sel_hi:[1,1,1] neg_lo:[1,0,0] neg_hi:[1,0,0]
    v_pk_fma_f32 v[94:95], v[54:55], v[124:125], v[94:95] op_sel:[0,1,0] op_sel_hi:[1,1,1] neg_lo:[1,0,0] neg_hi:[1,0,0]
    v_pk_mul_f32 v[60:61], v[92:93], v[128:129] op_sel:[0,1] op_sel_hi:[1,1]
    v_pk_mul_f32 v[62:63], v[94:95], v[128:129] op_sel:[0,1] op_sel_hi:[1,1]
    v_pk_fma_f32 v[92:93], v[92:93], v[126:127], s[50:51] op_sel:[0,1,0] op_sel_hi:[1,1,1]
    v_pk_fma_f32 v[94:95], v[94:95], v[126:127], s[50:51] op_sel:[0,1,0] op_sel_hi:[1,1,1]
    v_exp_f32 v60, v60 clamp
    v_exp_f32 v61, v61 clamp
    v_exp_f32 v62, v62 clamp
    v_exp_f32 v63, v63 clamp
    v_max_f32 v92, s50, v92
    v_max_f32 v93, s50, v93
    v_max_f32 v94, s50, v94
    v_max_f32 v95, s50, v95
    v_pk_add_f32 v[92:93], v[92:93], v[60:61]
    v_pk_add_f32 v[94:95], v[94:95], v[62:63]
    v_cvt_pk_bf16_f32 v74, v92, v93
    v_cvt_pk_bf16_f32 v75, v94, v95
    buffer_store_dwordx4 v[72:75], v18, s[16:19], s46 offen offset:1024 sc1
L_b2_10:
    s_and_b32 s47, s38, 1
    s_lshl_b32 s47, s47, 13
    s_add_u32 s46, s47, 4096
    s_bitcmp1_b32 s38, 1
    s_cselect_b32 s46, 16384, s46
    s_bitcmp1_b32 s38, 2
    s_cselect_b32 s47, 16384, s47
    v_add_u32 v120, s46, v18
    v_add_u32 v121, s47, v18
    s_waitcnt lgkmcnt(0)
    s_barrier
    ds_read_b128 v[24:27], v120 offset:43008
    ds_read_b128 v[28:31], v121 offset:43008
    ds_read_b128 v[32:35], v120 offset:44032
    ds_read_b128 v[36:39], v121 offset:44032
    ds_read_b128 v[40:43], v120 offset:45056
    ds_read_b128 v[44:47], v121 offset:45056
    ds_read_b128 v[48:51], v120 offset:46080
    ds_read_b128 v[52:55], v121 offset:46080
    s_cmp_lt_u32 s38, 6
    s_cbranch_scc1 L_nopqx_16
    v_and_b32 v122, 3, v0
    v_lshlrev_b32 v122, 8, v122
    v_bfe_u32 v123, v0, 2, 2
    v_lshl_add_u32 v122, v123, 4, v122
    v_lshrrev_b32 v123, 5, v0
    v_lshl_add_u32 v122, v123, 10, v122
    v_and_b32 v123, 1, v17
    v_lshl_add_u32 v122, v123, 3, v122
    s_and_b32 s47, s38, 1
    s_lshl_b32 s46, s47, 11
    v_add_u32 v122, s46, v122
    ds_read_b64_tr_b16 v[124:125], v122 offset:59392
    v_lshlrev_b32 v123, 2, v16
    v_lshl_add_u32 v123, v17, 8, v123
    s_lshl_b32 s46, s36, 1
    s_add_u32 s46, s46, s47
    s_lshl_b32 s46, s46, 13
    s_lshr_b32 s47, s37, 1
    s_lshl_b32 s47, s47, 10
    s_add_u32 s46, s46, s47
    s_and_b32 s47, s37, 1
    s_lshl_b32 s47, s47, 7
    s_add_u32 s46, s46, s47
    s_add_u32 s46, s46, 23330816
    s_waitcnt lgkmcnt(0)
    buffer_store_dword v124, v123, s[16:19], s46 offen offset:0 sc1
    buffer_store_dword v125, v123, s[16:19], s46 offen offset:64 sc1
L_nopqx_16:
    s_waitcnt lgkmcnt(6)
    v_mfma_f32_16x16x32_bf16 v[80:83], v[24:27], v[28:31], 0
    s_waitcnt lgkmcnt(4)
    v_mfma_f32_16x16x32_bf16 v[80:83], v[32:35], v[36:39], v[80:83]
    s_waitcnt lgkmcnt(2)
    v_mfma_f32_16x16x32_bf16 v[80:83], v[40:43], v[44:47], v[80:83]
    s_waitcnt lgkmcnt(0)
    v_mfma_f32_16x16x32_bf16 v[80:83], v[48:51], v[52:55], v[80:83]
    s_mov_b32 s48, 0x40000
L_poll_17:
    v_cmp_eq_u32 vcc, 0, v19
    s_cbranch_vccz L_go_18
    buffer_load_ubyte v19, v16, s[24:27], 0 offen sc1
    s_sub_u32 s48, s48, 1
    s_waitcnt vmcnt(0)
    s_cbranch_scc0 L_poll_17
L_go_18:
    s_nop 3
    s_cmp_lt_u32 s38, 4
    s_cbranch_scc1 L_wide_19
    v_cmp_eq_u32 vcc, 1, v13
    v_mov_b32_dpp v84, v81 row_shr:2 row_mask:0xf bank_mask:0xf
    v_cndmask_b32 v80, v80, v84, vcc
    v_cmp_eq_u32 vcc, 2, v13
    v_mov_b32_dpp v84, v82 row_shr:4 row_mask:0xf bank_mask:0xf
    v_cndmask_b32 v80, v80, v84, vcc
    v_cmp_eq_u32 vcc, 3, v13
    v_mov_b32_dpp v84, v83 row_shr:6 row_mask:0xf bank_mask:0xf
    v_cndmask_b32 v80, v80, v84, vcc
    buffer_atomic_add_f32 v80, v12, s[20:23], 0 offen sc1
    s_branch L_done_20
L_wide_19:
    buffer_atomic_add_f32 v80, v12, s[20:23], 0 offen sc1
    buffer_atomic_add_f32 v81, v13, s[20:23], 0 offen sc1
    buffer_atomic_add_f32 v82, v14, s[20:23], 0 offen sc1
    buffer_atomic_add_f32 v83, v15, s[20:23], 0 offen sc1
L_done_20:
    s_cmp_eq_u32 s38, 5
    s_cselect_b32 s46, s2, 255
    s_cmp_ge_u32 s46, 72
    s_cbranch_scc1 L_fin_21
    v_mov_b32 v120, 0
    v_mov_b32 v121, 0
    v_dot2c_f32_bf16 v120, v160, v20
    v_dot2c_f32_bf16 v121, v161, v20
    v_dot2c_f32_bf16 v120, v162, v20
    v_dot2c_f32_bf16 v121, v163, v20
    v_dot2c_f32_bf16 v120, v164, v20
    v_dot2c_f32_bf16 v121, v165, v20
    v_dot2c_f32_bf16 v120, v166, v20
    v_dot2c_f32_bf16 v121, v167, v20
    v_dot2c_f32_bf16 v120, v168, v20
    v_dot2c_f32_bf16 v121, v169, v20
    v_dot2c_f32_bf16 v120, v170, v20
    v_dot2c_f32_bf16 v121, v171, v20
    v_dot2c_f32_bf16 v120, v172, v20
    v_dot2c_f32_bf16 v121, v173, v20
    v_dot2c_f32_bf16 v120, v174, v20
    v_dot2c_f32_bf16 v121, v175, v20
    v_dot2c_f32_bf16 v120, v176, v20
    v_dot2c_f32_bf16 v121, v177, v20
    v_dot2c_f32_bf16 v120, v178, v20
    v_dot2c_f32_bf16 v121, v179, v20
    v_dot2c_f32_bf16 v120, v180, v20
    v_dot2c_f32_bf16 v121, v181, v20
    v_dot2c_f32_bf16 v120, v182, v20
    v_dot2c_f32_bf16 v121, v183, v20
    v_dot2c_f32_bf16 v120, v184, v20
    v_dot2c_f32_bf16 v121, v185, v20
    v_dot2c_f32_bf16 v120, v186, v20
    v_dot2c_f32_bf16 v121, v187, v20
    v_dot2c_f32_bf16 v120, v188, v20
    v_dot2c_f32_bf16 v121, v189, v20
    v_dot2c_f32_bf16 v120, v190, v20
    v_dot2c_f32_bf16 v121, v191, v20
    v_dot2c_f32_bf16 v120, v192, v20
    v_dot2c_f32_bf16 v121, v193, v20
    v_dot2c_f32_bf16 v120, v194, v20
    v_dot2c_f32_bf16 v121, v195, v20
    s_nop 2
    v_add_f32 v120, v120, v121
    s_nop 1
    v_add_f32_dpp v120, v120, v120 quad_perm:[1,0,3,2] row_mask:0xf bank_mask:0xf
    s_nop 1
    v_add_f32_dpp v120, v120, v120 quad_perm:[2,3,0,1] row_mask:0xf bank_mask:0xf
    s_nop 1
    v_add_f32_dpp v120, v120, v120 row_half_mirror row_mask:0xf bank_mask:0xf
    v_mul_f32 v120, 0x3ae38e39, v120
    v_cvt_pk_bf16_f32 v121, v120, v120
    v_and_b32 v122, 0xffff0000, v121
    v_sub_f32 v122, v120, v122
    v_cvt_pk_bf16_f32 v122, v120, v122
    v_mov_b32 v123, 0
    v_and_b32 v120, 0x38, v0
    s_lshl_b32 s46, s2, 6
    s_add_u32 s46, s46, 23789568
    s_mov_b32 exec_lo, 0x01010101
    s_mov_b32 exec_hi, 0x01010101
    buffer_store_dwordx2 v[122:123], v120, s[16:19], s46 offen sc1
    s_mov_b64 exec, -1
L_fin_21:
    s_and_b32 s45, s36, 0
    s_lshl_b32 s45, s45, 4
    s_add_u32 s45, s45, s37
    s_lshl_b32 s45, s45, 11
    s_add_u32 s45, s45, 23811072
    s_lshl_b32 s46, s36, 5
    s_add_u32 s46, s46, s37
    s_lshl_b32 s46, s46, 2
    s_add_u32 s46, s46, 23811072
    s_mov_b32 s22, s38
    s_load_dwordx4 s[48:51], s[0:1], 32
    s_and_b32 s26, s2, 7
    s_lshl_b32 s26, s26, 2
    s_lshr_b32 s27, s2, 6
    s_add_u32 s20, s26, s27
    s_bfe_u32 s21, s2, 0x30003
    v_lshlrev_b32 v3, 4, v0
    s_lshl_b32 s26, s22, 13
    s_add_u32 s29, s26, 0
    s_and_b32 s23, s22, 3
    s_lshr_b32 s24, s22, 2
    s_mul_i32 s44, s21, 144
    s_lshl_b32 s43, s22, 10
    s_lshl_b32 s26, s22, 6
    v_lshlrev_b32 v188, 4, v0
    v_add_u32 v188, 162304, v188
    v_mov_b32 v184, 0
    v_mov_b32 v185, 0
    v_mov_b32 v186, 0
    v_mov_b32 v187, 0
    ds_write_b128 v188, v[184:187]
    v_lshlrev_b32 v180, 11, v0
    v_mov_b32 v181, 1
    s_waitcnt vmcnt(0) lgkmcnt(0)
    s_barrier
    s_cmp_lg_u32 s22, 7
    s_cbranch_scc1 L_noflag_22
    s_mov_b64 exec, 0xffff
    buffer_store_dword v181, v180, s[16:19], s46 offen sc1
    s_mov_b64 exec, -1
L_noflag_22:
    v_and_b32 v1, 15, v0
    v_lshrrev_b32 v2, 4, v0
    v_lshl_add_u32 v180, v2, 4, s29
    v_lshl_add_u32 v23, v1, 6, v180
    v_and_b32 v181, 3, v0
    v_lshrrev_b32 v182, 2, v1
    v_add_u32 v183, 16, v182
    v_cmp_gt_u32 vcc, 8, v1
    v_cndmask_b32 v183, 19, v183, vcc
    v_cmp_eq_u32 vcc, 0, v181
    v_cndmask_b32 v183, 19, v183, vcc
    v_cmp_ne_u32 vcc, 1, v181
    v_cndmask_b32 v184, 18, v183, vcc
    v_lshl_add_u32 v24, v184, 6, v180
    v_add_u32 v183, 14, v182
    v_cmp_le_u32 vcc, 8, v1
    v_cndmask_b32 v183, 19, v183, vcc
    v_cmp_eq_u32 vcc, 0, v181
    v_cndmask_b32 v183, 19, v183, vcc
    v_cmp_ne_u32 vcc, 2, v181
    v_cndmask_b32 v185, 18, v183, vcc
    v_lshl_add_u32 v25, v185, 6, v180
    s_add_u32 s26, s29, 1280
    v_cmp_eq_u32 vcc, 0, v2
    v_cndmask_b32 v183, 19, v1, vcc
    v_lshl_add_u32 v26, v183, 3, s26
    v_cndmask_b32 v183, 19, v184, vcc
    v_lshl_add_u32 v30, v183, 3, s26
    v_cmp_eq_u32 vcc, 1, v2
    v_cndmask_b32 v183, 19, v1, vcc
    v_lshl_add_u32 v27, v183, 3, s26
    v_cndmask_b32 v183, 19, v185, vcc
    v_lshl_add_u32 v31, v183, 3, s26
    v_cmp_eq_u32 vcc, 2, v2
    v_cndmask_b32 v183, 19, v1, vcc
    v_lshl_add_u32 v28, v183, 3, s26
    v_cndmask_b32 v183, 19, v184, vcc
    v_lshl_add_u32 v32, v183, 3, s26
    v_cmp_eq_u32 vcc, 3, v2
    v_cndmask_b32 v183, 19, v1, vcc
    v_lshl_add_u32 v29, v183, 3, s26
    v_cndmask_b32 v183, 19, v185, vcc
    v_lshl_add_u32 v33, v183, 3, s26
    v_mov_b32 v35, 0
    v_mov_b32 v41, 0
    v_mov_b32 v47, 0
    v_mov_b32 v49, 0
    v_mov_b32 v55, 0
    v_mov_b32 v61, 0
    v_mov_b32 v63, 0
    v_mov_b32 v69, 0
    v_mov_b32 v75, 0
    v_mov_b32 v77, 0
    v_mov_b32 v83, 0
    v_mov_b32 v89, 0
    v_mov_b32 v91, 0
    v_mov_b32 v95, 0
    v_mov_b32 v101, 0
    v_mov_b32 v105, 0
    v_mov_b32 v107, 0
    v_mov_b32 v111, 0
    v_mov_b32 v117, 0
    v_mov_b32 v121, 0
    v_add_u32 v21, s29, v3
    s_mul_i32 s26, s24, 40960
    s_lshl_b32 s27, s23, 2
    s_add_u32 s27, s27, s26
    s_add_u32 s27, s27, 65680
    v_mul_u32_u24 v180, 160, v0
    v_add_u32 v22, s27, v180
    s_mul_i32 s27, s23, 10240
    s_add_u32 s27, s27, s26
    s_add_u32 s27, s27, 65680
    v_add_u32 v20, s27, v180
    s_lshl_b32 s26, s24, 15
    s_lshl_b32 s27, s23, 10
    s_add_u32 s27, s27, 0
    s_add_u32 s28, s27, s26
    v_add_u32 v18, s28, v3
    s_xor_b32 s26, s26, 0x8000
    s_add_u32 s28, s27, s26
    v_add_u32 v19, s28, v3
    s_mov_b32 s40, -1
    s_mov_b32 s41, 0
    s_mov_b32 s42, 0x358637bd
    v_bfe_u32 v180, v0, 2, 2
    v_and_b32 v181, 3, v0
    s_mul_i32 s26, s24, 288
    v_lshl_add_u32 v182, v2, 2, v180
    v_add_u32 v182, s26, v182
    v_mul_u32_u24 v183, 36, v180
    s_add_u32 s26, s26, 16
    v_add3_u32 v183, v183, v2, s26
    s_lshl_b32 s26, s24, 6
    s_add_u32 s26, s26, 65536
    s_xor_b32 s27, s26, 64
    v_cmp_gt_u32 vcc, 2, v181
    v_mov_b32 v186, 160
    v_cndmask_b32 v186, 8, v186, vcc
    v_lshlrev_b32 v181, 3, v181
    v_add_u32 v187, 65664, v181
    v_mov_b32 v188, 157696
    v_cndmask_b32 v187, v188, v187, vcc
    v_mul_u32_u24 v184, 160, v182
    v_add3_u32 v9, v184, v181, s26
    v_add3_u32 v10, v184, v181, s27
    v_mad_u32_u24 v13, v182, v186, v187
    v_mul_u32_u24 v184, 20, v186
    v_add_u32 v14, v13, v184
    v_mul_u32_u24 v184, 160, v183
    v_add3_u32 v11, v184, v181, s26
    v_add3_u32 v12, v184, v181, s27
    v_mad_u32_u24 v16, v183, v186, v187
    v_mul_u32_u24 v184, 144, v186
    v_add_u32 v17, v16, v184
    v_mul_u32_u24 v15, 36, v186
    v_lshlrev_b32 v181, 2, v0
    s_mov_b32 m0, s29
    s_mul_i32 s26, s22, 6144
    s_add_u32 s26, s26, 23592960
    s_lshl_b32 s27, s20, 3
    s_add_u32 s27, s27, s22
    s_lshl_b32 s28, s27, 13
    s_add_u32 s28, s28, 21233664
    s_lshl_b32 s27, s27, 10
    s_add_u32 s27, s27, 23330816
    v_lshrrev_b32 v182, 2, v0
    v_and_b32 v183, 3, v0
    v_lshlrev_b32 v183, 4, v183
    v_lshl_add_u32 v182, v182, 7, v183
    s_lshr_b32 s47, s20, 1
    s_lshl_b32 s47, s47, 2
    s_lshl_b64 s[62:63], 15, s47
    s_lshl_b32 s59, s20, 2
    s_add_u32 s59, s59, s23
    s_mul_i32 s59, s59, 18432
    s_mul_i32 s58, s21, 144
    s_add_u32 s59, s59, s58
    s_lshl_b32 s58, s24, 6
    s_add_u32 s58, s58, s59
    v_mul_u32_u24 v236, 1152, v1
    v_lshrrev_b32 v237, 1, v2
    v_and_b32 v238, 1, v2
    v_lshl_add_u32 v237, v238, 1, v237
    v_lshl_add_u32 v237, v237, 4, v236
    buffer_load_dwordx4 v[170:173], v237, s[8:11], s58 offen
    buffer_load_dwordx4 v[174:177], v236, s[8:11], s59 offen offset:128
    v_lshlrev_b32 v188, 3, v0
    v_add_u32 v188, 162304, v188
    s_cmp_eq_u32 s22, 7
    s_cbranch_scc1 L_skip_25
    s_lshl_b32 s46, s47, 3
    s_lshl_b32 s47, s22, 2
    s_add_u32 s46, s46, s47
    s_add_u32 s46, s46, 162304
    v_mov_b32 v188, s46
    s_mov_b32 s46, 8388608
L_spin_23:
    ds_read_b32 v184, v188
    s_sub_u32 s46, s46, 1
    s_cbranch_scc1 L_got_24
    s_waitcnt lgkmcnt(0)
    v_cmp_ne_u32 vcc, 1, v184
    s_cbranch_vccnz L_spin_23
L_got_24:
    s_add_u32 s47, s28, 4096
    buffer_load_dword v34, v181, s[16:19], s27 offen offset:0
    buffer_load_dwordx4 v[36:39], v3, s[16:19], s28 offen offset:0
    buffer_load_dwordx4 v[42:45], v3, s[16:19], s47 offen offset:0
    buffer_load_dword v48, v181, s[16:19], s27 offen offset:256
    buffer_load_dwordx4 v[50:53], v3, s[16:19], s28 offen offset:1024
    buffer_load_dwordx4 v[56:59], v3, s[16:19], s47 offen offset:1024
    buffer_load_dword v62, v181, s[16:19], s27 offen offset:512
    buffer_load_dwordx4 v[64:67], v3, s[16:19], s28 offen offset:2048
    buffer_load_dwordx4 v[70:73], v3, s[16:19], s47 offen offset:2048
    buffer_load_dword v76, v181, s[16:19], s27 offen offset:768
    buffer_load_dwordx4 v[78:81], v3, s[16:19], s28 offen offset:3072
    buffer_load_dwordx4 v[84:87], v3, s[16:19], s47 offen offset:3072
L_skip_25:
    s_cmp_lg_u32 s22, 7
    s_cbranch_scc1 L_go_27
    s_mov_b32 s46, 262144
    s_setprio 3
L_poll_28:
    buffer_load_dwordx4 v[184:187], v182, s[16:19], s45 offen sc1
    s_sub_u32 s46, s46, 1
    s_cbranch_scc1 L_go_27
    s_waitcnt vmcnt(0) lgkmcnt(0)
    v_and_b32 v216, v184, v185
    v_and_b32 v217, v186, v187
    ds_write_b64 v188, v[216:217]
    v_and_b32 v189, v216, v217
    v_cmp_ne_u32 vcc, 1, v189
    s_and_b64 exec, exec, vcc
    s_cbranch_scc1 L_poll_28
L_go_27:
    s_mov_b64 exec, -1
    s_waitcnt lgkmcnt(0)
    s_barrier
    s_setprio 0
    s_cmp_lg_u32 s22, 7
    s_cbranch_scc1 L_late_26
    s_add_u32 s47, s28, 4096
    buffer_load_dword v34, v181, s[16:19], s27 offen offset:0
    buffer_load_dwordx4 v[36:39], v3, s[16:19], s28 offen offset:0
    buffer_load_dwordx4 v[42:45], v3, s[16:19], s47 offen offset:0
    buffer_load_dword v48, v181, s[16:19], s27 offen offset:256
    buffer_load_dwordx4 v[50:53], v3, s[16:19], s28 offen offset:1024
    buffer_load_dwordx4 v[56:59], v3, s[16:19], s47 offen offset:1024
    buffer_load_dword v62, v181, s[16:19], s27 offen offset:512
    buffer_load_dwordx4 v[64:67], v3, s[16:19], s28 offen offset:2048
    buffer_load_dwordx4 v[70:73], v3, s[16:19], s47 offen offset:2048
    buffer_load_dword v76, v181, s[16:19], s27 offen offset:768
    buffer_load_dwordx4 v[78:81], v3, s[16:19], s28 offen offset:3072
    buffer_load_dwordx4 v[84:87], v3, s[16:19], s47 offen offset:3072
L_late_26:
    buffer_load_dwordx4 v3, s[16:19], s26 offen offset:0 lds
    buffer_load_dwordx4 v3, s[16:19], s26 offen offset:1024 lds
    buffer_load_dwordx4 v3, s[16:19], s26 offen offset:2048 lds
    buffer_load_dwordx4 v3, s[16:19], s26 offen offset:3072 lds
    s_add_u32 m0, s29, 4096
    s_add_u32 s26, s26, 4096
    buffer_load_dwordx4 v3, s[16:19], s26 offen offset:0 lds
    buffer_load_dwordx4 v3, s[16:19], s26 offen offset:1024 lds
    s_cmp_lt_u32 s22, 2
    s_cbranch_scc1 L_nors_29
    s_cmp_eq_u32 s22, 7
    s_cbranch_scc1 L_nors_29
    s_add_u32 m0, s43, 155648
    s_add_u32 s47, s43, 23787520
    buffer_load_dwordx4 v3, s[16:19], s47 offen sc1 lds
L_nors_29:
    s_waitcnt vmcnt(1)
    s_cmp_eq_u32 s22, 7
    s_cselect_b32 s47, 0, s22
    s_cmp_ge_u32 s47, 2
    s_cbranch_scc1 L_nw_30
    s_waitcnt vmcnt(0)
L_nw_30:
    ds_read_b128 v[122:125], v23 offset:0
    ds_read_b64 v[126:127], v26 offset:0
    ds_read_b128 v[128:131], v24 offset:0
    ds_read_b64 v[132:133], v30 offset:0
    ds_read_b128 v[134:137], v23 offset:1536
    ds_read_b64 v[138:139], v27 offset:1536
    ds_read_b128 v[140:143], v25 offset:1536
    ds_read_b64 v[144:145], v31 offset:1536
    ds_read_b128 v[146:149], v23 offset:3072
    ds_read_b64 v[150:151], v28 offset:3072
    ds_read_b128 v[152:155], v24 offset:3072
    ds_read_b64 v[156:157], v32 offset:3072
    ds_read_b128 v[158:161], v23 offset:4608
    ds_read_b64 v[162:163], v29 offset:4608
    ds_read_b128 v[164:167], v25 offset:4608
    ds_read_b64 v[168:169], v33 offset:4608
    s_waitcnt lgkmcnt(12)
    v_cvt_pk_bf16_f32 v92, v122, v123
    v_cvt_pk_bf16_f32 v93, v124, v125
    v_cvt_pk_bf16_f32 v90, v126, v127
    v_cvt_pk_bf16_f32 v96, v128, v129
    v_cvt_pk_bf16_f32 v97, v130, v131
    v_cvt_pk_bf16_f32 v94, v132, v133
    s_waitcnt lgkmcnt(8)
    v_cvt_pk_bf16_f32 v98, v134, v135
    v_cvt_pk_bf16_f32 v99, v136, v137
    v_cvt_pk_bf16_f32 v100, v138, v139
    v_cvt_pk_bf16_f32 v102, v140, v141
    v_cvt_pk_bf16_f32 v103, v142, v143
    v_cvt_pk_bf16_f32 v104, v144, v145
    s_waitcnt lgkmcnt(4)
    v_cvt_pk_bf16_f32 v108, v146, v147
    v_cvt_pk_bf16_f32 v109, v148, v149
    v_cvt_pk_bf16_f32 v106, v150, v151
    v_cvt_pk_bf16_f32 v112, v152, v153
    v_cvt_pk_bf16_f32 v113, v154, v155
    v_cvt_pk_bf16_f32 v110, v156, v157
    s_waitcnt lgkmcnt(0)
    v_cvt_pk_bf16_f32 v114, v158, v159
    v_cvt_pk_bf16_f32 v115, v160, v161
    v_cvt_pk_bf16_f32 v116, v162, v163
    v_cvt_pk_bf16_f32 v118, v164, v165
    v_cvt_pk_bf16_f32 v119, v166, v167
    v_cvt_pk_bf16_f32 v120, v168, v169
    s_nop 0
    v_mov_b32 v40, v34
    v_mov_b32 v46, v34
    v_mfma_f32_16x16x32_bf16 v[130:133], v[94:97], v[34:37], 0
    v_mfma_f32_16x16x32_bf16 v[122:125], v[90:93], v[34:37], 0
    v_mfma_f32_16x16x32_bf16 v[126:129], v[98:101], v[38:41], 0
    v_mfma_f32_16x16x32_bf16 v[130:133], v[102:105], v[38:41], v[130:133]
    v_mfma_f32_16x16x32_bf16 v[142:145], v[110:113], v[40:43], 0
    v_mfma_f32_16x16x32_bf16 v[134:137], v[106:109], v[40:43], 0
    v_mfma_f32_16x16x32_bf16 v[138:141], v[114:117], v[44:47], 0
    v_mfma_f32_16x16x32_bf16 v[142:145], v[118:121], v[44:47], v[142:145]
    s_nop 1
    v_add_f32 v154, s42, v131
    v_add_f32 v155, s42, v132
    v_rcp_f32 v154, v154
    v_rcp_f32 v155, v155
    s_nop 0
    v_pk_mul_f32 v[122:123], v[122:123], v[154:155] op_sel:[0,0] op_sel_hi:[1,0]
    v_pk_mul_f32 v[124:125], v[124:125], v[154:155] op_sel:[0,0] op_sel_hi:[1,0]
    v_pk_mul_f32 v[126:127], v[126:127], v[154:155] op_sel:[0,1] op_sel_hi:[1,1]
    v_pk_mul_f32 v[128:129], v[128:129], v[154:155] op_sel:[0,1] op_sel_hi:[1,1]
    v_cndmask_b32 v156, v155, v154, s[40:41]
    v_cvt_pk_bf16_f32 v146, v122, v123
    v_cvt_pk_bf16_f32 v147, v124, v125
    v_cvt_pk_bf16_f32 v148, v126, v127
    v_cvt_pk_bf16_f32 v149, v128, v129
    v_mul_f32 v158, v130, v156
    ds_write_b128 v21, v[146:149] offset:0
    v_mov_b32 v54, v48
    v_mov_b32 v60, v48
    v_mfma_f32_16x16x32_bf16 v[130:133], v[94:97], v[48:51], 0
    v_mfma_f32_16x16x32_bf16 v[122:125], v[90:93], v[48:51], 0
    v_mfma_f32_16x16x32_bf16 v[126:129], v[98:101], v[52:55], 0
    v_mfma_f32_16x16x32_bf16 v[130:133], v[102:105], v[52:55], v[130:133]
    s_nop 1
    v_add_f32 v154, s42, v143
    v_add_f32 v155, s42, v144
    v_rcp_f32 v154, v154
    v_rcp_f32 v155, v155
    s_nop 0
    v_pk_mul_f32 v[134:135], v[134:135], v[154:155] op_sel:[0,0] op_sel_hi:[1,0]
    v_pk_mul_f32 v[136:137], v[136:137], v[154:155] op_sel:[0,0] op_sel_hi:[1,0]
    v_pk_mul_f32 v[138:139], v[138:139], v[154:155] op_sel:[0,1] op_sel_hi:[1,1]
    v_pk_mul_f32 v[140:141], v[140:141], v[154:155] op_sel:[0,1] op_sel_hi:[1,1]
    v_cndmask_b32 v156, v155, v154, s[40:41]
    v_cvt_pk_bf16_f32 v150, v134, v135
    v_cvt_pk_bf16_f32 v151, v136, v137
    v_cvt_pk_bf16_f32 v152, v138, v139
    v_cvt_pk_bf16_f32 v153, v140, v141
    v_mul_f32 v159, v142, v156
    ds_write_b128 v21, v[150:153] offset:4096
    v_cvt_pk_bf16_f32 v160, v158, v159
    ds_write_b32 v22, v160 offset:0
    v_mfma_f32_16x16x32_bf16 v[142:145], v[110:113], v[54:57], 0
    v_mfma_f32_16x16x32_bf16 v[134:137], v[106:109], v[54:57], 0
    v_mfma_f32_16x16x32_bf16 v[138:141], v[114:117], v[58:61], 0
    v_mfma_f32_16x16x32_bf16 v[142:145], v[118:121], v[58:61], v[142:145]
    s_nop 1
    v_add_f32 v154, s42, v131
    v_add_f32 v155, s42, v132
    v_rcp_f32 v154, v154
    v_rcp_f32 v155, v155
    s_nop 0
    v_pk_mul_f32 v[122:123], v[122:123], v[154:155] op_sel:[0,0] op_sel_hi:[1,0]
    v_pk_mul_f32 v[124:125], v[124:125], v[154:155] op_sel:[0,0] op_sel_hi:[1,0]
    v_pk_mul_f32 v[126:127], v[126:127], v[154:155] op_sel:[0,1] op_sel_hi:[1,1]
    v_pk_mul_f32 v[128:129], v[128:129], v[154:155] op_sel:[0,1] op_sel_hi:[1,1]
    v_cndmask_b32 v156, v155, v154, s[40:41]
    v_cvt_pk_bf16_f32 v146, v122, v123
    v_cvt_pk_bf16_f32 v147, v124, v125
    v_cvt_pk_bf16_f32 v148, v126, v127
    v_cvt_pk_bf16_f32 v149, v128, v129
    v_mul_f32 v158, v130, v156
    ds_write_b128 v21, v[146:149] offset:1024
    v_mov_b32 v68, v62
    v_mov_b32 v74, v62
    v_mfma_f32_16x16x32_bf16 v[130:133], v[94:97], v[62:65], 0
    v_mfma_f32_16x16x32_bf16 v[122:125], v[90:93], v[62:65], 0
    v_mfma_f32_16x16x32_bf16 v[126:129], v[98:101], v[66:69], 0
    v_mfma_f32_16x16x32_bf16 v[130:133], v[102:105], v[66:69], v[130:133]
    s_nop 1
    v_add_f32 v154, s42, v143
    v_add_f32 v155, s42, v144
    v_rcp_f32 v154, v154
    v_rcp_f32 v155, v155
    s_nop 0
    v_pk_mul_f32 v[134:135], v[134:135], v[154:155] op_sel:[0,0] op_sel_hi:[1,0]
    v_pk_mul_f32 v[136:137], v[136:137], v[154:155] op_sel:[0,0] op_sel_hi:[1,0]
    v_pk_mul_f32 v[138:139], v[138:139], v[154:155] op_sel:[0,1] op_sel_hi:[1,1]
    v_pk_mul_f32 v[140:141], v[140:141], v[154:155] op_sel:[0,1] op_sel_hi:[1,1]
    v_cndmask_b32 v156, v155, v154, s[40:41]
    v_cvt_pk_bf16_f32 v150, v134, v135
    v_cvt_pk_bf16_f32 v151, v136, v137
    v_cvt_pk_bf16_f32 v152, v138, v139
    v_cvt_pk_bf16_f32 v153, v140, v141
    v_mul_f32 v159, v142, v156
    ds_write_b128 v21, v[150:153] offset:5120
    v_cvt_pk_bf16_f32 v160, v158, v159
    ds_write_b32 v22, v160 offset:10240
    v_mfma_f32_16x16x32_bf16 v[142:145], v[110:113], v[68:71], 0
    v_mfma_f32_16x16x32_bf16 v[134:137], v[106:109], v[68:71], 0
    v_mfma_f32_16x16x32_bf16 v[138:141], v[114:117], v[72:75], 0
    v_mfma_f32_16x16x32_bf16 v[142:145], v[118:121], v[72:75], v[142:145]
    s_nop 1
    v_add_f32 v154, s42, v131
    v_add_f32 v155, s42, v132
    v_rcp_f32 v154, v154
    v_rcp_f32 v155, v155
    s_nop 0
    v_pk_mul_f32 v[122:123], v[122:123], v[154:155] op_sel:[0,0] op_sel_hi:[1,0]
    v_pk_mul_f32 v[124:125], v[124:125], v[154:155] op_sel:[0,0] op_sel_hi:[1,0]
    v_pk_mul_f32 v[126:127], v[126:127], v[154:155] op_sel:[0,1] op_sel_hi:[1,1]
    v_pk_mul_f32 v[128:129], v[128:129], v[154:155] op_sel:[0,1] op_sel_hi:[1,1]
    v_cndmask_b32 v156, v155, v154, s[40:41]
    v_cvt_pk_bf16_f32 v146, v122, v123
    v_cvt_pk_bf16_f32 v147, v124, v125
    v_cvt_pk_bf16_f32 v148, v126, v127
    v_cvt_pk_bf16_f32 v149, v128, v129
    v_mul_f32 v158, v130, v156
    ds_write_b128 v21, v[146:149] offset:2048
    v_mov_b32 v82, v76
    v_mov_b32 v88, v76
    v_mfma_f32_16x16x32_bf16 v[130:133], v[94:97], v[76:79], 0
    v_mfma_f32_16x16x32_bf16 v[122:125], v[90:93], v[76:79], 0
    v_mfma_f32_16x16x32_bf16 v[126:129], v[98:101], v[80:83], 0
    v_mfma_f32_16x16x32_bf16 v[130:133], v[102:105], v[80:83], v[130:133]
    s_nop 1
    v_add_f32 v154, s42, v143
    v_add_f32 v155, s42, v144
    v_rcp_f32 v154, v154
    v_rcp_f32 v155, v155
    s_nop 0
    v_pk_mul_f32 v[134:135], v[134:135], v[154:155] op_sel:[0,0] op_sel_hi:[1,0]
    v_pk_mul_f32 v[136:137], v[136:137], v[154:155] op_sel:[0,0] op_sel_hi:[1,0]
    v_pk_mul_f32 v[138:139], v[138:139], v[154:155] op_sel:[0,1] op_sel_hi:[1,1]
    v_pk_mul_f32 v[140:141], v[140:141], v[154:155] op_sel:[0,1] op_sel_hi:[1,1]
    v_cndmask_b32 v156, v155, v154, s[40:41]
    v_cvt_pk_bf16_f32 v150, v134, v135
    v_cvt_pk_bf16_f32 v151, v136, v137
    v_cvt_pk_bf16_f32 v152, v138, v139
    v_cvt_pk_bf16_f32 v153, v140, v141
    v_mul_f32 v159, v142, v156
    ds_write_b128 v21, v[150:153] offset:6144
    v_cvt_pk_bf16_f32 v160, v158, v159
    ds_write_b32 v22, v160 offset:20480
    v_mfma_f32_16x16x32_bf16 v[142:145], v[110:113], v[82:85], 0
    v_mfma_f32_16x16x32_bf16 v[134:137], v[106:109], v[82:85], 0
    v_mfma_f32_16x16x32_bf16 v[138:141], v[114:117], v[86:89], 0
    v_mfma_f32_16x16x32_bf16 v[142:145], v[118:121], v[86:89], v[142:145]
    s_nop 1
    v_add_f32 v154, s42, v131
    v_add_f32 v155, s42, v132
    v_rcp_f32 v154, v154
    v_rcp_f32 v155, v155
    s_nop 0
    v_pk_mul_f32 v[122:123], v[122:123], v[154:155] op_sel:[0,0] op_sel_hi:[1,0]
    v_pk_mul_f32 v[124:125], v[124:125], v[154:155] op_sel:[0,0] op_sel_hi:[1,0]
    v_pk_mul_f32 v[126:127], v[126:127], v[154:155] op_sel:[0,1] op_sel_hi:[1,1]
    v_pk_mul_f32 v[128:129], v[128:129], v[154:155] op_sel:[0,1] op_sel_hi:[1,1]
    v_cndmask_b32 v156, v155, v154, s[40:41]
    v_cvt_pk_bf16_f32 v146, v122, v123
    v_cvt_pk_bf16_f32 v147, v124, v125
    v_cvt_pk_bf16_f32 v148, v126, v127
    v_cvt_pk_bf16_f32 v149, v128, v129
    v_mul_f32 v158, v130, v156
    ds_write_b128 v21, v[146:149] offset:3072
    s_nop 5
    v_add_f32 v154, s42, v143
    v_add_f32 v155, s42, v144
    v_rcp_f32 v154, v154
    v_rcp_f32 v155, v155
    s_nop 0
    v_pk_mul_f32 v[134:135], v[134:135], v[154:155] op_sel:[0,0] op_sel_hi:[1,0]
    v_pk_mul_f32 v[136:137], v[136:137], v[154:155] op_sel:[0,0] op_sel_hi:[1,0]
    v_pk_mul_f32 v[138:139], v[138:139], v[154:155] op_sel:[0,1] op_sel_hi:[1,1]
    v_pk_mul_f32 v[140:141], v[140:141], v[154:155] op_sel:[0,1] op_sel_hi:[1,1]
    v_cndmask_b32 v156, v155, v154, s[40:41]
    v_cvt_pk_bf16_f32 v150, v134, v135
    v_cvt_pk_bf16_f32 v151, v136, v137
    v_cvt_pk_bf16_f32 v152, v138, v139
    v_cvt_pk_bf16_f32 v153, v140, v141
    v_mul_f32 v159, v142, v156
    ds_write_b128 v21, v[150:153] offset:7168
    v_cvt_pk_bf16_f32 v160, v158, v159
    ds_write_b32 v22, v160 offset:30720
    s_lshl_b32 s26, s20, 2
    s_add_u32 s20, s26, s23
    s_mul_i32 s26, s20, 18432
    s_mul_i32 s27, s21, 144
    s_add_u32 s26, s26, s27
    s_lshl_b32 s27, s24, 6
    s_add_u32 s27, s27, s26
    v_mul_u32_u24 v180, 1152, v1
    v_lshrrev_b32 v181, 1, v2
    v_and_b32 v182, 1, v2
    v_lshl_add_u32 v189, v182, 1, v181
    v_lshl_add_u32 v181, v189, 4, v180
    v_lshlrev_b32 v190, 2, v1
    s_lshl_b32 s28, s20, 6
    s_add_u32 s28, s28, 23642112
    s_mov_b32 s52, s50
    s_mov_b32 s53, s51
    s_mov_b32 s54, 5308416
    s_mov_b32 s55, 0x00020000
    s_mov_b32 s50, 5308416
    s_mov_b32 s51, 0x00020000
    s_lshl_b32 s58, s2, 3
    s_add_u32 s58, s58, s22
    s_mul_i32 s58, s58, 2592
    v_lshlrev_b32 v191, 7, v0
    s_waitcnt vmcnt(0) lgkmcnt(0)
    s_barrier
    buffer_load_dword v178, v190, s[16:19], s28 offen
    s_mov_b64 exec, 0x1fffff
    buffer_load_dword v193, v191, s[52:55], s58 offen
    s_mov_b64 exec, -1
    ds_read_b128 v[90:93], v18 offset:0
    ds_read_b64_tr_b16 v[34:35], v9 offset:0
    ds_read_b64_tr_b16 v[36:37], v9 offset:3200
    ds_read_b64_tr_b16 v[38:39], v9 offset:32
    ds_read_b64_tr_b16 v[40:41], v9 offset:3232
    ds_read_b64_tr_b16 v[42:43], v10 offset:0
    ds_read_b64_tr_b16 v[44:45], v10 offset:3200
    ds_read_b64_tr_b16 v[46:47], v10 offset:32
    ds_read_b64_tr_b16 v[48:49], v10 offset:3232
    ds_read_b64_tr_b16 v[50:51], v13 offset:0
    ds_read_b64_tr_b16 v[52:53], v14 offset:0
    v_add_u32 v13, v15, v13
    v_add_u32 v14, v15, v14
    s_waitcnt lgkmcnt(8)
    v_mfma_f32_16x16x32_bf16 v[196:199], v[34:37], v[90:93], 0
    ds_read_b128 v[94:97], v18 offset:4096
    ds_read_b64_tr_b16 v[54:55], v9 offset:5760
    ds_read_b64_tr_b16 v[56:57], v9 offset:8960
    s_mul_i32 s26, s21, 9
    s_lshl_b32 s27, s24, 2
    s_waitcnt lgkmcnt(9)
    v_mfma_f32_16x16x32_bf16 v[200:203], v[38:41], v[90:93], 0
    ds_read_b64_tr_b16 v[58:59], v9 offset:5792
    ds_read_b64_tr_b16 v[60:61], v9 offset:8992
    s_add_u32 s27, s27, s26
    v_add_u32 v189, s27, v189
    s_waitcnt lgkmcnt(9)
    v_mfma_f32_16x16x32_bf16 v[204:207], v[42:45], v[90:93], 0
    ds_read_b64_tr_b16 v[62:63], v10 offset:5760
    ds_read_b64_tr_b16 v[64:65], v10 offset:8960
    v_lshrrev_b32 v180, 2, v189
    v_and_b32 v189, 3, v189
    s_waitcnt lgkmcnt(9)
    v_mfma_f32_16x16x32_bf16 v[208:211], v[46:49], v[90:93], 0
    ds_read_b64_tr_b16 v[66:67], v10 offset:5792
    ds_read_b64_tr_b16 v[68:69], v10 offset:8992
    v_lshlrev_b32 v180, 12, v180
    v_lshl_add_u32 v180, v189, 8, v180
    s_waitcnt lgkmcnt(9)
    v_mfma_f32_16x16x32_bf16 v[212:215], v[50:53], v[90:93], 0
    ds_read_b64_tr_b16 v[70:71], v13 offset:0
    ds_read_b64_tr_b16 v[72:73], v14 offset:0
    v_add_u32 v13, v15, v13
    v_add_u32 v14, v15, v14
    v_lshl_add_u32 v189, v1, 4, v180
    v_add_u32 v180, 32, v1
    s_waitcnt lgkmcnt(8)
    v_mfma_f32_16x16x32_bf16 v[196:199], v[54:57], v[94:97], v[196:199]
    ds_read_b128 v[90:93], v18 offset:8192
    ds_read_b64_tr_b16 v[34:35], v9 offset:11520
    ds_read_b64_tr_b16 v[36:37], v9 offset:14720
    v_sub_u32 v180, v180, v0
    v_lshl_add_u32 v181, v180, 4, v19
    s_waitcnt lgkmcnt(9)
    v_mfma_f32_16x16x32_bf16 v[200:203], v[58:61], v[94:97], v[200:203]
    ds_read_b64_tr_b16 v[38:39], v9 offset:11552
    ds_read_b64_tr_b16 v[40:41], v9 offset:14752
    v_lshl_add_u32 v180, v180, 4, v18
    s_add_u32 s26, s26, 8
    s_waitcnt lgkmcnt(9)
    v_mfma_f32_16x16x32_bf16 v[204:207], v[62:65], v[94:97], v[204:207]
    ds_read_b64_tr_b16 v[42:43], v10 offset:11520
    ds_read_b64_tr_b16 v[44:45], v10 offset:14720
    s_lshr_b32 s27, s26, 2
    s_lshl_b32 s27, s27, 12
    s_waitcnt lgkmcnt(9)
    v_mfma_f32_16x16x32_bf16 v[208:211], v[66:69], v[94:97], v[208:211]
    ds_read_b64_tr_b16 v[46:47], v10 offset:11552
    ds_read_b64_tr_b16 v[48:49], v10 offset:14752
    s_and_b32 s26, s26, 3
    s_lshl_b32 s26, s26, 8
    s_waitcnt lgkmcnt(9)
    v_mfma_f32_16x16x32_bf16 v[212:215], v[70:73], v[94:97], v[212:215]
    ds_read_b64_tr_b16 v[50:51], v13 offset:0
    ds_read_b64_tr_b16 v[52:53], v14 offset:0
    v_add_u32 v13, v15, v13
    v_add_u32 v14, v15, v14
    s_add_u32 s28, s26, s27
    s_lshr_b32 s26, s20, 2
    s_waitcnt lgkmcnt(8)
    v_mfma_f32_16x16x32_bf16 v[196:199], v[34:37], v[90:93], v[196:199]
    ds_read_b128 v[94:97], v18 offset:12288
    ds_read_b64_tr_b16 v[54:55], v9 offset:17280
    ds_read_b64_tr_b16 v[56:57], v9 offset:20480
    s_mul_i32 s26, s26, 73728
    s_lshl_b32 s27, s23, 10
    s_waitcnt lgkmcnt(9)
    v_mfma_f32_16x16x32_bf16 v[200:203], v[38:41], v[90:93], v[200:203]
    ds_read_b64_tr_b16 v[58:59], v9 offset:17312
    ds_read_b64_tr_b16 v[60:61], v9 offset:20512
    s_add_u32 s29, s26, s27
    s_add_u32 s28, s28, s29
    s_waitcnt lgkmcnt(9)
    v_mfma_f32_16x16x32_bf16 v[204:207], v[42:45], v[90:93], v[204:207]
    ds_read_b64_tr_b16 v[62:63], v10 offset:17280
    ds_read_b64_tr_b16 v[64:65], v10 offset:20480
    v_lshlrev_b32 v220, 16, v170
    v_and_b32 v221, 0xffff0000, v170
    s_waitcnt lgkmcnt(9)
    v_mfma_f32_16x16x32_bf16 v[208:211], v[46:49], v[90:93], v[208:211]
    ds_read_b64_tr_b16 v[66:67], v10 offset:17312
    ds_read_b64_tr_b16 v[68:69], v10 offset:20512
    v_lshlrev_b32 v222, 16, v171
    v_and_b32 v223, 0xffff0000, v171
    s_waitcnt lgkmcnt(9)
    v_mfma_f32_16x16x32_bf16 v[212:215], v[50:53], v[90:93], v[212:215]
    ds_read_b64_tr_b16 v[70:71], v13 offset:0
    ds_read_b64_tr_b16 v[72:73], v14 offset:0
    v_add_u32 v13, v15, v13
    v_add_u32 v14, v15, v14
    v_lshlrev_b32 v224, 16, v172
    v_and_b32 v225, 0xffff0000, v172
    s_waitcnt lgkmcnt(8)
    v_mfma_f32_16x16x32_bf16 v[196:199], v[54:57], v[94:97], v[196:199]
    ds_read_b128 v[90:93], v18 offset:16384
    ds_read_b64_tr_b16 v[34:35], v9 offset:23040
    ds_read_b64_tr_b16 v[36:37], v9 offset:26240
    v_lshlrev_b32 v226, 16, v173
    v_and_b32 v227, 0xffff0000, v173
    s_waitcnt lgkmcnt(9)
    v_mfma_f32_16x16x32_bf16 v[200:203], v[58:61], v[94:97], v[200:203]
    ds_read_b64_tr_b16 v[38:39], v9 offset:23072
    ds_read_b64_tr_b16 v[40:41], v9 offset:26272
    v_lshlrev_b32 v228, 16, v174
    v_and_b32 v229, 0xffff0000, v174
    s_waitcnt lgkmcnt(9)
    v_mfma_f32_16x16x32_bf16 v[204:207], v[62:65], v[94:97], v[204:207]
    ds_read_b64_tr_b16 v[42:43], v10 offset:23040
    ds_read_b64_tr_b16 v[44:45], v10 offset:26240
    v_lshlrev_b32 v230, 16, v175
    v_and_b32 v231, 0xffff0000, v175
    s_waitcnt lgkmcnt(9)
    v_mfma_f32_16x16x32_bf16 v[208:211], v[66:69], v[94:97], v[208:211]
    ds_read_b64_tr_b16 v[46:47], v10 offset:23072
    ds_read_b64_tr_b16 v[48:49], v10 offset:26272
    v_lshlrev_b32 v232, 16, v176
    v_and_b32 v233, 0xffff0000, v176
    s_waitcnt lgkmcnt(9)
    v_mfma_f32_16x16x32_bf16 v[212:215], v[70:73], v[94:97], v[212:215]
    ds_read_b64_tr_b16 v[50:51], v13 offset:0
    ds_read_b64_tr_b16 v[52:53], v14 offset:0
    v_add_u32 v13, v15, v13
    v_add_u32 v14, v15, v14
    v_lshlrev_b32 v234, 16, v177
    v_and_b32 v235, 0xffff0000, v177
    s_waitcnt lgkmcnt(8)
    v_mfma_f32_16x16x32_bf16 v[196:199], v[34:37], v[90:93], v[196:199]
    ds_read_b128 v[94:97], v18 offset:20480
    ds_read_b64_tr_b16 v[54:55], v9 offset:28800
    ds_read_b64_tr_b16 v[56:57], v9 offset:32000
    s_waitcnt lgkmcnt(9)
    v_mfma_f32_16x16x32_bf16 v[200:203], v[38:41], v[90:93], v[200:203]
    ds_read_b64_tr_b16 v[58:59], v9 offset:28832
    ds_read_b64_tr_b16 v[60:61], v9 offset:32032
    s_waitcnt lgkmcnt(9)
    v_mfma_f32_16x16x32_bf16 v[204:207], v[42:45], v[90:93], v[204:207]
    ds_read_b64_tr_b16 v[62:63], v10 offset:28800
    ds_read_b64_tr_b16 v[64:65], v10 offset:32000
    s_waitcnt lgkmcnt(9)
    v_mfma_f32_16x16x32_bf16 v[208:211], v[46:49], v[90:93], v[208:211]
    ds_read_b64_tr_b16 v[66:67], v10 offset:28832
    ds_read_b64_tr_b16 v[68:69], v10 offset:32032
    s_waitcnt lgkmcnt(9)
    v_mfma_f32_16x16x32_bf16 v[212:215], v[50:53], v[90:93], v[212:215]
    ds_read_b64_tr_b16 v[70:71], v13 offset:0
    ds_read_b64_tr_b16 v[72:73], v14 offset:0
    v_add_u32 v13, v15, v13
    v_add_u32 v14, v15, v14
    s_waitcnt lgkmcnt(8)
    v_mfma_f32_16x16x32_bf16 v[196:199], v[54:57], v[94:97], v[196:199]
    ds_read_b128 v[90:93], v18 offset:24576
    ds_read_b64_tr_b16 v[34:35], v9 offset:34560
    ds_read_b64_tr_b16 v[36:37], v9 offset:37760
    s_waitcnt lgkmcnt(9)
    v_mfma_f32_16x16x32_bf16 v[200:203], v[58:61], v[94:97], v[200:203]
    ds_read_b64_tr_b16 v[38:39], v9 offset:34592
    ds_read_b64_tr_b16 v[40:41], v9 offset:37792
    s_waitcnt lgkmcnt(9)
    v_mfma_f32_16x16x32_bf16 v[204:207], v[62:65], v[94:97], v[204:207]
    ds_read_b64_tr_b16 v[42:43], v10 offset:34560
    ds_read_b64_tr_b16 v[44:45], v10 offset:37760
    s_waitcnt lgkmcnt(9)
    v_mfma_f32_16x16x32_bf16 v[208:211], v[66:69], v[94:97], v[208:211]
    ds_read_b64_tr_b16 v[46:47], v10 offset:34592
    ds_read_b64_tr_b16 v[48:49], v10 offset:37792
    s_waitcnt lgkmcnt(9)
    v_mfma_f32_16x16x32_bf16 v[212:215], v[70:73], v[94:97], v[212:215]
    ds_read_b64_tr_b16 v[50:51], v13 offset:0
    ds_read_b64_tr_b16 v[52:53], v14 offset:0
    v_add_u32 v13, v15, v13
    v_add_u32 v14, v15, v14
    s_waitcnt lgkmcnt(8)
    v_mfma_f32_16x16x32_bf16 v[196:199], v[34:37], v[90:93], v[196:199]
    ds_read_b128 v[94:97], v18 offset:28672
    ds_read_b64_tr_b16 v[54:55], v9 offset:40320
    ds_read_b64_tr_b16 v[56:57], v9 offset:43520
    s_waitcnt lgkmcnt(9)
    v_mfma_f32_16x16x32_bf16 v[200:203], v[38:41], v[90:93], v[200:203]
    ds_read_b64_tr_b16 v[58:59], v9 offset:40352
    ds_read_b64_tr_b16 v[60:61], v9 offset:43552
    s_waitcnt lgkmcnt(9)
    v_mfma_f32_16x16x32_bf16 v[204:207], v[42:45], v[90:93], v[204:207]
    ds_read_b64_tr_b16 v[62:63], v10 offset:40320
    ds_read_b64_tr_b16 v[64:65], v10 offset:43520
    s_waitcnt lgkmcnt(9)
    v_mfma_f32_16x16x32_bf16 v[208:211], v[46:49], v[90:93], v[208:211]
    ds_read_b64_tr_b16 v[66:67], v10 offset:40352
    ds_read_b64_tr_b16 v[68:69], v10 offset:43552
    s_waitcnt lgkmcnt(9)
    v_mfma_f32_16x16x32_bf16 v[212:215], v[50:53], v[90:93], v[212:215]
    ds_read_b64_tr_b16 v[70:71], v13 offset:0
    ds_read_b64_tr_b16 v[72:73], v14 offset:0
    s_waitcnt lgkmcnt(8)
    v_mfma_f32_16x16x32_bf16 v[196:199], v[54:57], v[94:97], v[196:199]
    ds_read_b128 v[90:93], v20
    ds_read_b64_tr_b16 v[34:35], v11 offset:0
    ds_read_b64_tr_b16 v[36:37], v11 offset:23040
    s_waitcnt lgkmcnt(9)
    v_mfma_f32_16x16x32_bf16 v[200:203], v[58:61], v[94:97], v[200:203]
    ds_read_b64_tr_b16 v[38:39], v11 offset:32
    ds_read_b64_tr_b16 v[40:41], v11 offset:23072
    s_waitcnt lgkmcnt(9)
    v_mfma_f32_16x16x32_bf16 v[204:207], v[62:65], v[94:97], v[204:207]
    ds_read_b64_tr_b16 v[42:43], v12 offset:0
    ds_read_b64_tr_b16 v[44:45], v12 offset:23040
    s_waitcnt lgkmcnt(9)
    v_mfma_f32_16x16x32_bf16 v[208:211], v[66:69], v[94:97], v[208:211]
    ds_read_b64_tr_b16 v[46:47], v12 offset:32
    ds_read_b64_tr_b16 v[48:49], v12 offset:23072
    s_waitcnt lgkmcnt(9)
    v_mfma_f32_16x16x32_bf16 v[212:215], v[70:73], v[94:97], v[212:215]
    ds_read_b64_tr_b16 v[50:51], v16 offset:0
    ds_read_b64_tr_b16 v[52:53], v17 offset:0
    s_waitcnt lgkmcnt(8)
    v_mfma_f32_16x16x32_bf16 v[196:199], v[34:37], v[90:93], v[196:199]
    s_waitcnt lgkmcnt(6)
    v_mfma_f32_16x16x32_bf16 v[200:203], v[38:41], v[90:93], v[200:203]
    s_waitcnt lgkmcnt(4)
    v_mfma_f32_16x16x32_bf16 v[204:207], v[42:45], v[90:93], v[204:207]
    s_waitcnt lgkmcnt(2)
    v_mfma_f32_16x16x32_bf16 v[208:211], v[46:49], v[90:93], v[208:211]
    s_waitcnt lgkmcnt(0)
    v_mfma_f32_16x16x32_bf16 v[212:215], v[50:53], v[90:93], v[212:215]
    ds_write_b128 v18, v[204:207] offset:0
    ds_write_b128 v18, v[208:211] offset:4096
    ds_write_b128 v18, v[212:215] offset:8192
    s_waitcnt lgkmcnt(0)
    s_barrier
    ds_read_b64 v[46:47], v180 offset:8192
    ds_read_b64 v[48:49], v181 offset:8192
    ds_read_b128 v[34:37], v19 offset:0
    ds_read_b128 v[38:41], v19 offset:4096
    ds_read_b128 v[42:45], v19 offset:8192
    s_waitcnt vmcnt(1)
    s_waitcnt lgkmcnt(3)
    v_pk_add_f32 v[46:47], v[46:47], v[48:49]
    v_add_f32 v46, v46, v47
    v_add_f32 v178, v178, v46
    s_waitcnt lgkmcnt(1)
    v_pk_add_f32 v[196:197], v[196:197], v[34:35]
    v_pk_add_f32 v[198:199], v[198:199], v[36:37]
    v_pk_add_f32 v[200:201], v[200:201], v[38:39]
    v_pk_add_f32 v[202:203], v[202:203], v[40:41]
    s_nop 1
    v_permlane16_swap_b32 v196, v200
    v_permlane16_swap_b32 v197, v201
    v_permlane16_swap_b32 v198, v202
    v_permlane16_swap_b32 v199, v203
    v_pk_add_f32 v[220:221], v[220:221], v[178:179] op_sel:[0,0] op_sel_hi:[1,0] neg_lo:[0,1] neg_hi:[0,1]
    v_pk_add_f32 v[220:221], v[220:221], v[196:197]
    v_pk_add_f32 v[222:223], v[222:223], v[178:179] op_sel:[0,0] op_sel_hi:[1,0] neg_lo:[0,1] neg_hi:[0,1]
    v_pk_add_f32 v[222:223], v[222:223], v[198:199]
    v_pk_add_f32 v[224:225], v[224:225], v[178:179] op_sel:[0,0] op_sel_hi:[1,0] neg_lo:[0,1] neg_hi:[0,1]
    v_pk_add_f32 v[224:225], v[224:225], v[200:201]
    v_pk_add_f32 v[226:227], v[226:227], v[178:179] op_sel:[0,0] op_sel_hi:[1,0] neg_lo:[0,1] neg_hi:[0,1]
    v_pk_add_f32 v[226:227], v[226:227], v[202:203]
    v_pk_mul_f32 v[46:47], v[220:221], v[220:221]
    v_pk_fma_f32 v[46:47], v[222:223], v[222:223], v[46:47]
    v_pk_fma_f32 v[46:47], v[224:225], v[224:225], v[46:47]
    v_pk_fma_f32 v[46:47], v[226:227], v[226:227], v[46:47]
    v_cvt_pk_bf16_f32 v196, v220, v221
    v_cvt_pk_bf16_f32 v197, v222, v223
    v_cvt_pk_bf16_f32 v198, v224, v225
    v_cvt_pk_bf16_f32 v199, v226, v227
    buffer_store_dwordx4 v[196:199], v189, s[16:19], s29 offen
    s_cmp_lg_u32 s24, 0
    s_cbranch_scc1 L_no4_31
    s_waitcnt lgkmcnt(0)
    v_pk_add_f32 v[212:213], v[212:213], v[42:43]
    v_pk_add_f32 v[214:215], v[214:215], v[44:45]
    s_nop 1
    v_permlane16_swap_b32 v212, v208
    v_permlane16_swap_b32 v213, v209
    v_permlane16_swap_b32 v214, v210
    v_permlane16_swap_b32 v215, v211
    s_mov_b64 exec, 0xffff
    v_pk_add_f32 v[228:229], v[228:229], v[178:179] op_sel:[0,0] op_sel_hi:[1,0] neg_lo:[0,1] neg_hi:[0,1]
    v_pk_add_f32 v[228:229], v[228:229], v[212:213]
    v_pk_add_f32 v[230:231], v[230:231], v[178:179] op_sel:[0,0] op_sel_hi:[1,0] neg_lo:[0,1] neg_hi:[0,1]
    v_pk_add_f32 v[230:231], v[230:231], v[214:215]
    v_pk_add_f32 v[232:233], v[232:233], v[178:179] op_sel:[0,0] op_sel_hi:[1,0] neg_lo:[0,1] neg_hi:[0,1]
    v_pk_add_f32 v[232:233], v[232:233], v[208:209]
    v_pk_add_f32 v[234:235], v[234:235], v[178:179] op_sel:[0,0] op_sel_hi:[1,0] neg_lo:[0,1] neg_hi:[0,1]
    v_pk_add_f32 v[234:235], v[234:235], v[210:211]
    v_pk_fma_f32 v[46:47], v[228:229], v[228:229], v[46:47]
    v_pk_fma_f32 v[46:47], v[230:231], v[230:231], v[46:47]
    v_pk_fma_f32 v[46:47], v[232:233], v[232:233], v[46:47]
    v_pk_fma_f32 v[46:47], v[234:235], v[234:235], v[46:47]
    v_cvt_pk_bf16_f32 v212, v228, v229
    v_cvt_pk_bf16_f32 v213, v230, v231
    v_cvt_pk_bf16_f32 v214, v232, v233
    v_cvt_pk_bf16_f32 v215, v234, v235
    buffer_store_dwordx4 v[212:215], v3, s[16:19], s28 offen
    s_cmp_lg_u32 s21, 0
    s_cbranch_scc1 L_no4_31
    s_lshl_b32 s28, s20, 6
    s_add_u32 s28, s28, 23650304
    buffer_store_dword v178, v190, s[16:19], s28 offen
L_no4_31:
    s_mov_b64 exec, -1
    v_add_f32 v46, v46, v47
    v_mov_b32 v47, v46
    s_nop 1
    v_permlane32_swap_b32 v46, v47
    v_add_f32 v46, v46, v47
    v_mov_b32 v47, v46
    s_nop 1
    v_permlane16_swap_b32 v46, v47
    v_add_f32 v46, v46, v47
    s_lshl_b32 s26, s20, 10
    s_lshl_b32 s27, s21, 1
    s_add_u32 s27, s27, s24
    s_lshl_b32 s27, s27, 2
    s_add_u32 s26, s26, s27
    s_add_u32 s26, s26, 23658496
    v_lshlrev_b32 v180, 6, v0
    s_mov_b64 exec, 0xffff
    buffer_store_dword v46, v180, s[16:19], s26 offen
L_exit_1:
    s_endpgm
.globl sequential_preLN__linear_attn_block__dense_activation_relu__prompt_kernel
.p2align 8
.type sequential_preLN__linear_attn_block__dense_activation_relu__prompt_kernel,@function
sequential_preLN__linear_attn_block__dense_activation_relu__prompt_kernel:
    s_cmp_ge_u32 s2, 256
    s_cbranch_scc1 L_exit_32
    s_load_dwordx4 s[24:27], s[0:1], 32
    s_load_dwordx2 s[4:5], s[0:1], 48
    s_load_dwordx2 s[6:7], s[0:1], 64
    v_lshrrev_b32 v10, 6, v0
    v_and_b32 v0, 63, v0
    v_readfirstlane_b32 s30, v10
    v_lshlrev_b32 v1, 4, v0
    s_and_b32 s33, s2, 3
    s_lshl_b32 s33, s33, 1
    s_bfe_u32 s34, s2, 65539
    s_add_u32 s28, s33, s34
    s_bfe_u32 s33, s2, 65538
    s_lshl_b32 s33, s33, 4
    s_lshr_b32 s34, s2, 4
    s_add_u32 s29, s33, s34
    v_lshrrev_b32 v10, 3, v0
    v_and_b32 v10, 2, v10
    v_xor_b32 v10, v10, v0
    v_and_b32 v10, 3, v10
    v_lshlrev_b32 v10, 4, v10
    v_lshrrev_b32 v11, 2, v0
    v_lshrrev_b32 v12, 4, v0
    v_lshl_add_u32 v13, v12, 2, v11
    s_movk_i32 s33, 9216
    v_mad_u32_u24 v5, v13, s33, v10
    v_add_u32 v6, 35840, v5
    s_movk_i32 s33, 1152
    v_mad_u32_u24 v7, v11, s33, v10
    v_add_u32 v8, 17408, v7
    s_mul_i32 s32, s30, 18432
    s_add_u32 s32, s32, 73728
    s_mul_i32 s58, s29, 73728
    s_lshl_b32 s33, s29, 1
    s_add_u32 s33, s33, s30
    s_mul_i32 s34, s28, 1152
    s_and_b32 s35, s33, 15
    s_lshl_b32 s36, s35, 6
    s_add_u32 s40, s36, s34
    s_lshl_b32 s36, s30, 10
    s_add_u32 s37, s58, s36
    s_waitcnt lgkmcnt(0)
    s_mov_b32 s16, s6
    s_mov_b32 s17, s7
    s_mov_b32 s18, 23942144
    s_mov_b32 s19, 0x00020000
    s_mov_b32 s8, s24
    s_mov_b32 s9, s25
    s_mov_b32 s10, 5308416
    s_mov_b32 s11, 0x00020000
    s_mov_b32 s65, s36
    s_mov_b32 s66, s37
    s_add_u32 m0, s65, 0
    s_nop 0
    buffer_load_dwordx4 v1, s[16:19], s66 offen lds
    s_add_u32 m0, s65, 4096
    s_add_u32 s66, s66, 4096
    buffer_load_dwordx4 v1, s[16:19], s66 offen lds
    s_add_u32 m0, s65, 8192
    s_add_u32 s66, s66, 4096
    buffer_load_dwordx4 v1, s[16:19], s66 offen lds
    s_add_u32 m0, s65, 12288
    s_add_u32 s66, s66, 4096
    buffer_load_dwordx4 v1, s[16:19], s66 offen lds
    s_add_u32 m0, s65, 16384
    s_add_u32 s66, s66, 4096
    buffer_load_dwordx4 v1, s[16:19], s66 offen lds
    s_add_u32 m0, s32, 0
    s_mov_b32 s31, s40
    buffer_load_dwordx4 v5, s[8:11], s31 offen lds
    s_add_u32 m0, s32, 0
    s_nop 0
    buffer_load_dwordx4 v6, s[8:11], s31 offen offset:1024 lds
    s_add_u32 m0, s65, 20480
    s_add_u32 s66, s66, 4096
    buffer_load_dwordx4 v1, s[16:19], s66 offen lds
    s_add_u32 m0, s32, 2048
    s_add_u32 s31, s31, 294912
    buffer_load_dwordx4 v5, s[8:11], s31 offen lds
    s_add_u32 m0, s32, 2048
    s_nop 0
    buffer_load_dwordx4 v6, s[8:11], s31 offen offset:1024 lds
    s_add_u32 m0, s65, 24576
    s_add_u32 s66, s66, 4096
    buffer_load_dwordx4 v1, s[16:19], s66 offen lds
    s_add_u32 m0, s32, 4096
    s_add_u32 s31, s31, 294912
    buffer_load_dwordx4 v5, s[8:11], s31 offen lds
    s_add_u32 m0, s32, 4096
    s_nop 0
    buffer_load_dwordx4 v6, s[8:11], s31 offen offset:1024 lds
    s_add_u32 m0, s65, 28672
    s_add_u32 s66, s66, 4096
    buffer_load_dwordx4 v1, s[16:19], s66 offen lds
    s_add_u32 m0, s32, 6144
    s_add_u32 s31, s31, 294912
    buffer_load_dwordx4 v5, s[8:11], s31 offen lds
    s_add_u32 m0, s32, 6144
    s_nop 0
    buffer_load_dwordx4 v6, s[8:11], s31 offen offset:1024 lds
    s_add_u32 m0, s65, 32768
    s_add_u32 s66, s66, 4096
    buffer_load_dwordx4 v1, s[16:19], s66 offen lds
    s_add_u32 m0, s32, 8192
    s_add_u32 s31, s31, 294912
    buffer_load_dwordx4 v5, s[8:11], s31 offen lds
    s_add_u32 m0, s32, 8192
    s_nop 0
    buffer_load_dwordx4 v6, s[8:11], s31 offen offset:1024 lds
    s_add_u32 m0, s65, 36864
    s_add_u32 s66, s66, 4096
    buffer_load_dwordx4 v1, s[16:19], s66 offen lds
    s_add_u32 m0, s32, 10240
    s_add_u32 s31, s31, 294912
    buffer_load_dwordx4 v5, s[8:11], s31 offen lds
    s_add_u32 m0, s32, 10240
    s_nop 0
    buffer_load_dwordx4 v6, s[8:11], s31 offen offset:1024 lds
    s_mov_b32 s12, s26
    s_mov_b32 s13, s27
    s_mov_b32 s14, 5308416
    s_mov_b32 s15, 0x00020000
    s_mov_b32 s20, s4
    s_mov_b32 s21, s5
    s_mov_b32 s22, 2359296
    s_mov_b32 s23, 0x00020000
    s_mul_i32 s37, s28, 663552
    s_add_u32 s35, s33, 0
    s_and_b32 s35, s35, 15
    s_lshl_b32 s50, s35, 12
    s_lshl_b32 s36, s28, 1
    s_cmp_ge_u32 s35, s36
    s_cselect_b32 s36, 2, 0
    s_add_u32 s35, s35, s36
    s_lshl_b32 s36, s35, 6
    s_add_u32 s45, s36, s37
    s_lshl_b32 s54, s35, 15
    s_add_u32 s35, s33, 4
    s_and_b32 s35, s35, 15
    s_lshl_b32 s51, s35, 12
    s_lshl_b32 s36, s35, 6
    s_add_u32 s41, s36, s34
    s_lshl_b32 s36, s28, 1
    s_cmp_ge_u32 s35, s36
    s_cselect_b32 s36, 2, 0
    s_add_u32 s35, s35, s36
    s_lshl_b32 s36, s35, 6
    s_add_u32 s46, s36, s37
    s_lshl_b32 s55, s35, 15
    s_add_u32 s35, s33, 8
    s_and_b32 s35, s35, 15
    s_lshl_b32 s52, s35, 12
    s_lshl_b32 s36, s35, 6
    s_add_u32 s42, s36, s34
    s_lshl_b32 s36, s28, 1
    s_cmp_ge_u32 s35, s36
    s_cselect_b32 s36, 2, 0
    s_add_u32 s35, s35, s36
    s_lshl_b32 s36, s35, 6
    s_add_u32 s47, s36, s37
    s_lshl_b32 s56, s35, 15
    s_add_u32 s35, s33, 12
    s_and_b32 s35, s35, 15
    s_lshl_b32 s53, s35, 12
    s_lshl_b32 s36, s35, 6
    s_add_u32 s43, s36, s34
    s_lshl_b32 s36, s28, 1
    s_cmp_ge_u32 s35, s36
    s_cselect_b32 s36, 2, 0
    s_add_u32 s35, s35, s36
    s_lshl_b32 s36, s35, 6
    s_add_u32 s48, s36, s37
    s_lshl_b32 s57, s35, 15
    s_mul_i32 s33, s29, 589824
    s_add_u32 s33, s33, 2359296
    s_lshl_b32 s35, s28, 12
    s_add_u32 s35, s35, s33
    s_add_u32 s54, s54, s35
    s_add_u32 s55, s55, s35
    s_add_u32 s56, s56, s35
    s_add_u32 s57, s57, s35
    s_lshr_b32 s35, s30, 1
    s_and_b32 s36, s30, 1
    s_lshl_b32 s44, s35, 6
    s_add_u32 s44, s44, s34
    s_mul_i32 s34, s36, 2654208
    s_add_u32 s34, s34, 1024
    s_add_u32 s44, s44, s34
    s_lshl_b32 s34, s28, 1
    s_add_u32 s34, s34, s35
    s_lshl_b32 s49, s34, 6
    s_add_u32 s49, s49, s37
    s_mul_i32 s37, s36, 331776
    s_add_u32 s49, s49, s37
    v_and_b32 v10, 15, v0
    v_lshlrev_b32 v144, 2, v10
    v_lshlrev_b32 v145, 6, v10
    v_lshl_add_u32 v145, v12, 4, v145
    v_add_u32 v2, 0x10000, v1
    v_lshlrev_b32 v13, 6, v11
    v_and_b32 v14, 3, v0
    v_lshl_add_u32 v13, v14, 3, v13
    v_and_b32 v15, 1, v12
    v_lshl_add_u32 v13, v15, 5, v13
    v_add_u32 v3, s32, v13
    v_xor_b32 v4, 32, v3
    v_lshrrev_b32 v13, 3, v10
    v_lshl_add_u32 v13, v13, 2, v14
    v_and_b32 v14, 1, v13
    v_lshlrev_b32 v14, 4, v14
    s_movk_i32 s35, 0x3f80
    v_lshlrev_b32 v14, v14, s35
    v_lshrrev_b32 v13, 1, v13
    v_lshrrev_b32 v15, 1, v10
    v_and_b32 v15, 2, v15
    v_sub_u32 v15, v12, v15
    v_lshl_add_u32 v13, v15, 2, v13
    v_cmp_eq_u32 vcc, 0, v13
    v_cndmask_b32 v172, 0, v14, vcc
    v_cmp_eq_u32 vcc, 1, v13
    v_cndmask_b32 v173, 0, v14, vcc
    v_cmp_eq_u32 vcc, 2, v13
    v_cndmask_b32 v174, 0, v14, vcc
    v_cmp_eq_u32 vcc, 3, v13
    v_cndmask_b32 v175, 0, v14, vcc
    v_cmp_eq_u32 vcc, 4, v13
    v_cndmask_b32 v176, 0, v14, vcc
    v_cmp_eq_u32 vcc, 5, v13
    v_cndmask_b32 v177, 0, v14, vcc
    v_cmp_eq_u32 vcc, 6, v13
    v_cndmask_b32 v178, 0, v14, vcc
    v_cmp_eq_u32 vcc, 7, v13
    v_cndmask_b32 v179, 0, v14, vcc
    v_mul_u32_u24 v14, 1152, v10
    v_lshl_add_u32 v14, v12, 4, v14
    s_lshl_b32 s35, s30, 12
    s_add_u32 s35, s35, 147456
    v_add_u32 v10, s35, v1
    v_xor_b32 v11, 0x1000, v10
    s_waitcnt vmcnt(17)
    s_barrier
    ds_read_b128 a[0:3], v1 offset:0
    ds_read_b128 a[4:7], v1 offset:1024
    ds_read_b128 a[8:11], v1 offset:2048
    ds_read_b128 a[12:15], v1 offset:3072
    ds_read_b128 a[16:19], v1 offset:4096
    ds_read_b128 a[20:23], v1 offset:5120
    ds_read_b128 a[24:27], v1 offset:6144
    ds_read_b128 a[28:31], v1 offset:7168
    s_waitcnt vmcnt(15)
    ds_read_b64_tr_b16 v[16:17], v3 offset:0
    ds_read_b64_tr_b16 v[18:19], v3 offset:1024
    ds_read_b64_tr_b16 v[20:21], v4 offset:0
    ds_read_b64_tr_b16 v[22:23], v4 offset:1024
    s_waitcnt vmcnt(12) lgkmcnt(2)
    v_mfma_f32_16x16x32_bf16 v[32:35], v[16:19], a[0:3], 0
    ds_read_b64_tr_b16 v[24:25], v3 offset:2048
    ds_read_b64_tr_b16 v[26:27], v3 offset:3072
    v_mfma_f32_16x16x32_bf16 v[40:43], v[16:19], a[4:7], 0
    s_add_u32 m0, s65, 40960
    s_add_u32 s66, s66, 4096
    buffer_load_dwordx4 v1, s[16:19], s66 offen lds
    v_mfma_f32_16x16x32_bf16 v[48:51], v[16:19], a[8:11], 0
    ds_read_b128 a[32:35], v1 offset:8192
    ds_read_b128 a[36:39], v1 offset:9216
    v_mfma_f32_16x16x32_bf16 v[56:59], v[16:19], a[12:15], 0
    s_add_u32 m0, s32, 12288
    s_add_u32 s31, s31, 294912
    buffer_load_dwordx4 v5, s[8:11], s31 offen lds
    s_waitcnt lgkmcnt(4)
    v_mfma_f32_16x16x32_bf16 v[36:39], v[20:23], a[0:3], 0
    ds_read_b64_tr_b16 v[28:29], v4 offset:2048
    ds_read_b64_tr_b16 v[30:31], v4 offset:3072
    v_mfma_f32_16x16x32_bf16 v[44:47], v[20:23], a[4:7], 0
    s_add_u32 m0, s32, 12288
    s_nop 0
    buffer_load_dwordx4 v6, s[8:11], s31 offen offset:1024 lds
    v_mfma_f32_16x16x32_bf16 v[52:55], v[20:23], a[8:11], 0
    s_add_u32 m0, s65, 45056
    s_add_u32 s66, s66, 4096
    buffer_load_dwordx4 v1, s[16:19], s66 offen lds
    v_mfma_f32_16x16x32_bf16 v[60:63], v[20:23], a[12:15], 0
    ds_read_b128 a[40:43], v1 offset:10240
    ds_read_b128 a[44:47], v1 offset:11264
    s_waitcnt vmcnt(13) lgkmcnt(6)
    v_mfma_f32_16x16x32_bf16 v[32:35], v[24:27], a[16:19], v[32:35]
    ds_read_b64_tr_b16 v[16:17], v3 offset:4096
    ds_read_b64_tr_b16 v[18:19], v3 offset:5120
    v_mfma_f32_16x16x32_bf16 v[40:43], v[24:27], a[20:23], v[40:43]
    s_add_u32 m0, s32, 14336
    s_add_u32 s31, s31, 294912
    buffer_load_dwordx4 v5, s[8:11], s31 offen lds
    v_mfma_f32_16x16x32_bf16 v[48:51], v[24:27], a[24:27], v[48:51]
    ds_read_b128 a[48:51], v1 offset:12288
    ds_read_b128 a[52:55], v1 offset:13312
    v_mfma_f32_16x16x32_bf16 v[56:59], v[24:27], a[28:31], v[56:59]
    s_add_u32 m0, s32, 14336
    s_nop 0
    buffer_load_dwordx4 v6, s[8:11], s31 offen offset:1024 lds
    s_waitcnt lgkmcnt(6)
    v_mfma_f32_16x16x32_bf16 v[36:39], v[28:31], a[16:19], v[36:39]
    ds_read_b64_tr_b16 v[20:21], v4 offset:4096
    ds_read_b64_tr_b16 v[22:23], v4 offset:5120
    v_mfma_f32_16x16x32_bf16 v[44:47], v[28:31], a[20:23], v[44:47]
    s_add_u32 m0, s65, 49152
    s_add_u32 s66, s66, 4096
    buffer_load_dwordx4 v1, s[16:19], s66 offen lds
    v_mfma_f32_16x16x32_bf16 v[52:55], v[28:31], a[24:27], v[52:55]
    s_add_u32 m0, s32, 16384
    s_add_u32 s31, s31, 294912
    buffer_load_dwordx4 v5, s[8:11], s31 offen lds
    v_mfma_f32_16x16x32_bf16 v[60:63], v[28:31], a[28:31], v[60:63]
    ds_read_b128 a[56:59], v1 offset:14336
    ds_read_b128 a[60:63], v1 offset:15360
    s_waitcnt vmcnt(14) lgkmcnt(6)
    v_mfma_f32_16x16x32_bf16 v[32:35], v[16:19], a[32:35], v[32:35]
    ds_read_b64_tr_b16 v[24:25], v3 offset:6144
    ds_read_b64_tr_b16 v[26:27], v3 offset:7168
    v_mfma_f32_16x16x32_bf16 v[40:43], v[16:19], a[36:39], v[40:43]
    s_add_u32 m0, s32, 16384
    s_nop 0
    buffer_load_dwordx4 v6, s[8:11], s31 offen offset:1024 lds
    v_mfma_f32_16x16x32_bf16 v[48:51], v[16:19], a[40:43], v[48:51]
    ds_read_b128 a[64:67], v1 offset:16384
    ds_read_b128 a[68:71], v1 offset:17408
    v_mfma_f32_16x16x32_bf16 v[56:59], v[16:19], a[44:47], v[56:59]
    s_add_u32 m0, s65, 53248
    s_add_u32 s66, s66, 4096
    buffer_load_dwordx4 v1, s[16:19], s66 offen lds
    s_waitcnt lgkmcnt(6)
    v_mfma_f32_16x16x32_bf16 v[36:39], v[20:23], a[32:35], v[36:39]
    ds_read_b64_tr_b16 v[28:29], v4 offset:6144
    ds_read_b64_tr_b16 v[30:31], v4 offset:7168
    v_mfma_f32_16x16x32_bf16 v[44:47], v[20:23], a[36:39], v[44:47]
    s_add_u32 m0, s32, 0
    s_add_u32 s31, s31, 294912
    buffer_load_dwordx4 v5, s[8:11], s31 offen lds
    v_mfma_f32_16x16x32_bf16 v[52:55], v[20:23], a[40:43], v[52:55]
    s_add_u32 m0, s32, 0
    s_nop 0
    buffer_load_dwordx4 v6, s[8:11], s31 offen offset:1024 lds
    v_mfma_f32_16x16x32_bf16 v[60:63], v[20:23], a[44:47], v[60:63]
    ds_read_b128 a[72:75], v1 offset:18432
    ds_read_b128 a[76:79], v1 offset:19456
    s_barrier
    s_waitcnt vmcnt(15) lgkmcnt(6)
    v_mfma_f32_16x16x32_bf16 v[32:35], v[24:27], a[48:51], v[32:35]
    ds_read_b64_tr_b16 v[16:17], v3 offset:8192
    ds_read_b64_tr_b16 v[18:19], v3 offset:9216
    v_mfma_f32_16x16x32_bf16 v[40:43], v[24:27], a[52:55], v[40:43]
    s_add_u32 m0, s65, 57344
    s_add_u32 s66, s66, 4096
    buffer_load_dwordx4 v1, s[16:19], s66 offen lds
    v_mfma_f32_16x16x32_bf16 v[48:51], v[24:27], a[56:59], v[48:51]
    ds_read_b128 a[80:83], v1 offset:20480
    ds_read_b128 a[84:87], v1 offset:21504
    v_mfma_f32_16x16x32_bf16 v[56:59], v[24:27], a[60:63], v[56:59]
    s_add_u32 m0, s32, 2048
    s_add_u32 s31, s31, 294912
    buffer_load_dwordx4 v5, s[8:11], s31 offen lds
    s_waitcnt lgkmcnt(6)
    v_mfma_f32_16x16x32_bf16 v[36:39], v[28:31], a[48:51], v[36:39]
    ds_read_b64_tr_b16 v[20:21], v4 offset:8192
    ds_read_b64_tr_b16 v[22:23], v4 offset:9216
    v_mfma_f32_16x16x32_bf16 v[44:47], v[28:31], a[52:55], v[44:47]
    s_add_u32 m0, s32, 2048
    s_nop 0
    buffer_load_dwordx4 v6, s[8:11], s31 offen offset:1024 lds
    v_mfma_f32_16x16x32_bf16 v[52:55], v[28:31], a[56:59], v[52:55]
    s_add_u32 m0, s65, 61440
    s_add_u32 s66, s66, 4096
    buffer_load_dwordx4 v1, s[16:19], s66 offen lds
    v_mfma_f32_16x16x32_bf16 v[60:63], v[28:31], a[60:63], v[60:63]
    ds_read_b128 a[88:91], v1 offset:22528
    ds_read_b128 a[92:95], v1 offset:23552
    s_waitcnt vmcnt(16) lgkmcnt(6)
    v_mfma_f32_16x16x32_bf16 v[32:35], v[16:19], a[64:67], v[32:35]
    ds_read_b64_tr_b16 v[24:25], v3 offset:10240
    ds_read_b64_tr_b16 v[26:27], v3 offset:11264
    v_mfma_f32_16x16x32_bf16 v[40:43], v[16:19], a[68:71], v[40:43]
    s_add_u32 m0, s32, 4096
    s_add_u32 s31, s31, 294912
    buffer_load_dwordx4 v5, s[8:11], s31 offen lds
    v_mfma_f32_16x16x32_bf16 v[48:51], v[16:19], a[72:75], v[48:51]
    ds_read_b128 a[96:99], v1 offset:24576
    ds_read_b128 a[100:103], v1 offset:25600
    v_mfma_f32_16x16x32_bf16 v[56:59], v[16:19], a[76:79], v[56:59]
    s_add_u32 m0, s32, 4096
    s_nop 0
    buffer_load_dwordx4 v6, s[8:11], s31 offen offset:1024 lds
    s_waitcnt lgkmcnt(6)
    v_mfma_f32_16x16x32_bf16 v[36:39], v[20:23], a[64:67], v[36:39]
    ds_read_b64_tr_b16 v[28:29], v4 offset:10240
    ds_read_b64_tr_b16 v[30:31], v4 offset:11264
    v_mfma_f32_16x16x32_bf16 v[44:47], v[20:23], a[68:71], v[44:47]
    s_add_u32 m0, s65, 65536
    s_add_u32 s66, s66, 4096
    buffer_load_dwordx4 v1, s[16:19], s66 offen lds
    v_mfma_f32_16x16x32_bf16 v[52:55], v[20:23], a[72:75], v[52:55]
    s_add_u32 m0, s32, 6144
    s_add_u32 s31, s31, 294912
    buffer_load_dwordx4 v5, s[8:11], s31 offen lds
    v_mfma_f32_16x16x32_bf16 v[60:63], v[20:23], a[76:79], v[60:63]
    ds_read_b128 a[104:107], v1 offset:26624
    ds_read_b128 a[108:111], v1 offset:27648
    s_waitcnt vmcnt(17) lgkmcnt(6)
    v_mfma_f32_16x16x32_bf16 v[32:35], v[24:27], a[80:83], v[32:35]
    ds_read_b64_tr_b16 v[16:17], v3 offset:12288
    ds_read_b64_tr_b16 v[18:19], v3 offset:13312
    v_mfma_f32_16x16x32_bf16 v[40:43], v[24:27], a[84:87], v[40:43]
    s_add_u32 m0, s32, 6144
    s_nop 0
    buffer_load_dwordx4 v6, s[8:11], s31 offen offset:1024 lds
    v_mfma_f32_16x16x32_bf16 v[48:51], v[24:27], a[88:91], v[48:51]
    ds_read_b128 a[112:115], v1 offset:28672
    ds_read_b128 a[116:119], v1 offset:29696
    v_mfma_f32_16x16x32_bf16 v[56:59], v[24:27], a[92:95], v[56:59]
    s_add_u32 m0, s65, 69632
    s_add_u32 s66, s66, 4096
    buffer_load_dwordx4 v1, s[16:19], s66 offen lds
    s_waitcnt lgkmcnt(6)
    v_mfma_f32_16x16x32_bf16 v[36:39], v[28:31], a[80:83], v[36:39]
    ds_read_b64_tr_b16 v[20:21], v4 offset:12288
    ds_read_b64_tr_b16 v[22:23], v4 offset:13312
    v_mfma_f32_16x16x32_bf16 v[44:47], v[28:31], a[84:87], v[44:47]
    s_add_u32 m0, s32, 8192
    s_add_u32 s31, s31, 294912
    buffer_load_dwordx4 v5, s[8:11], s31 offen lds
    v_mfma_f32_16x16x32_bf16 v[52:55], v[28:31], a[88:91], v[52:55]
    s_add_u32 m0, s32, 8192
    s_nop 0
    buffer_load_dwordx4 v6, s[8:11], s31 offen offset:1024 lds
    v_mfma_f32_16x16x32_bf16 v[60:63], v[28:31], a[92:95], v[60:63]
    ds_read_b128 a[120:123], v1 offset:30720
    ds_read_b128 a[124:127], v1 offset:31744
    s_barrier
    s_waitcnt vmcnt(18) lgkmcnt(6)
    v_mfma_f32_16x16x32_bf16 v[32:35], v[16:19], a[96:99], v[32:35]
    ds_read_b64_tr_b16 v[24:25], v3 offset:14336
    ds_read_b64_tr_b16 v[26:27], v3 offset:15360
    v_mfma_f32_16x16x32_bf16 v[40:43], v[16:19], a[100:103], v[40:43]
    s_add_u32 m0, s32, 10240
    s_add_u32 s31, s31, 294912
    buffer_load_dwordx4 v5, s[8:11], s31 offen lds
    v_mfma_f32_16x16x32_bf16 v[48:51], v[16:19], a[104:107], v[48:51]
    ds_read_b128 a[128:131], v1 offset:32768
    ds_read_b128 a[132:135], v1 offset:33792
    v_mfma_f32_16x16x32_bf16 v[56:59], v[16:19], a[108:111], v[56:59]
    s_add_u32 m0, s32, 10240
    s_nop 0
    buffer_load_dwordx4 v6, s[8:11], s31 offen offset:1024 lds
    s_waitcnt lgkmcnt(6)
    v_mfma_f32_16x16x32_bf16 v[36:39], v[20:23], a[96:99], v[36:39]
    ds_read_b64_tr_b16 v[28:29], v4 offset:14336
    ds_read_b64_tr_b16 v[30:31], v4 offset:15360
    v_mfma_f32_16x16x32_bf16 v[44:47], v[20:23], a[100:103], v[44:47]
    s_add_u32 m0, s32, 12288
    s_add_u32 s31, s31, 294912
    buffer_load_dwordx4 v5, s[8:11], s31 offen lds
    v_mfma_f32_16x16x32_bf16 v[52:55], v[20:23], a[104:107], v[52:55]
    ds_read_b128 a[136:139], v1 offset:34816
    ds_read_b128 a[140:143], v1 offset:35840
    v_mfma_f32_16x16x32_bf16 v[60:63], v[20:23], a[108:111], v[60:63]
    s_waitcnt vmcnt(18) lgkmcnt(6)
    v_mfma_f32_16x16x32_bf16 v[32:35], v[24:27], a[112:115], v[32:35]
    ds_read_b64_tr_b16 v[16:17], v3 offset:16384
    ds_read_b64_tr_b16 v[18:19], v3 offset:17408
    v_mfma_f32_16x16x32_bf16 v[40:43], v[24:27], a[116:119], v[40:43]
    buffer_load_dwordx4 v6, s[8:11], s31 offen offset:1024 lds
    ds_read_b128 a[144:147], v1 offset:36864
    v_mfma_f32_16x16x32_bf16 v[48:51], v[24:27], a[120:123], v[48:51]
    ds_read_b128 a[148:151], v1 offset:37888
    ds_read_b128 a[152:155], v1 offset:38912
    v_mfma_f32_16x16x32_bf16 v[56:59], v[24:27], a[124:127], v[56:59]
    s_add_u32 m0, s32, 14336
    s_add_u32 s31, s31, 294912
    s_waitcnt lgkmcnt(7)
    v_mfma_f32_16x16x32_bf16 v[36:39], v[28:31], a[112:115], v[36:39]
    ds_read_b64_tr_b16 v[20:21], v4 offset:16384
    ds_read_b64_tr_b16 v[22:23], v4 offset:17408
    v_mfma_f32_16x16x32_bf16 v[44:47], v[28:31], a[116:119], v[44:47]
    buffer_load_dwordx4 v5, s[8:11], s31 offen lds
    ds_read_b128 a[156:159], v1 offset:39936
    v_mfma_f32_16x16x32_bf16 v[52:55], v[28:31], a[120:123], v[52:55]
    v_mfma_f32_16x16x32_bf16 v[60:63], v[28:31], a[124:127], v[60:63]
    s_waitcnt vmcnt(17) lgkmcnt(6)
    v_mfma_f32_16x16x32_bf16 v[32:35], v[16:19], a[128:131], v[32:35]
    ds_read_b64_tr_b16 v[24:25], v3 offset:0
    ds_read_b64_tr_b16 v[26:27], v3 offset:1024
    v_mfma_f32_16x16x32_bf16 v[40:43], v[16:19], a[132:135], v[40:43]
    buffer_load_dwordx4 v6, s[8:11], s31 offen offset:1024 lds
    ds_read_b128 a[160:163], v1 offset:40960
    v_mfma_f32_16x16x32_bf16 v[48:51], v[16:19], a[136:139], v[48:51]
    ds_read_b128 a[164:167], v1 offset:41984
    ds_read_b128 a[168:171], v1 offset:43008
    v_mfma_f32_16x16x32_bf16 v[56:59], v[16:19], a[140:143], v[56:59]
    s_add_u32 m0, s32, 16384
    s_add_u32 s31, s31, 294912
    s_waitcnt lgkmcnt(6)
    v_mfma_f32_16x16x32_bf16 v[36:39], v[20:23], a[128:131], v[36:39]
    ds_read_b64_tr_b16 v[28:29], v4 offset:0
    ds_read_b64_tr_b16 v[30:31], v4 offset:1024
    v_mfma_f32_16x16x32_bf16 v[44:47], v[20:23], a[132:135], v[44:47]
    buffer_load_dwordx4 v5, s[8:11], s31 offen lds
    ds_read_b128 a[172:175], v1 offset:44032
    v_mfma_f32_16x16x32_bf16 v[52:55], v[20:23], a[136:139], v[52:55]
    v_mfma_f32_16x16x32_bf16 v[60:63], v[20:23], a[140:143], v[60:63]
    s_barrier
    s_waitcnt vmcnt(16) lgkmcnt(6)
    v_mfma_f32_16x16x32_bf16 v[32:35], v[24:27], a[144:147], v[32:35]
    ds_read_b64_tr_b16 v[16:17], v3 offset:2048
    ds_read_b64_tr_b16 v[18:19], v3 offset:3072
    v_mfma_f32_16x16x32_bf16 v[40:43], v[24:27], a[148:151], v[40:43]
    buffer_load_dwordx4 v6, s[8:11], s31 offen offset:1024 lds
    ds_read_b128 a[176:179], v1 offset:45056
    v_mfma_f32_16x16x32_bf16 v[48:51], v[24:27], a[152:155], v[48:51]
    ds_read_b128 a[180:183], v1 offset:46080
    ds_read_b128 a[184:187], v1 offset:47104
    v_mfma_f32_16x16x32_bf16 v[56:59], v[24:27], a[156:159], v[56:59]
    s_add_u32 m0, s32, 0
    s_mov_b32 s31, s41
    s_waitcnt lgkmcnt(6)
    v_mfma_f32_16x16x32_bf16 v[36:39], v[28:31], a[144:147], v[36:39]
    ds_read_b64_tr_b16 v[20:21], v4 offset:2048
    ds_read_b64_tr_b16 v[22:23], v4 offset:3072
    v_mfma_f32_16x16x32_bf16 v[44:47], v[28:31], a[148:151], v[44:47]
    buffer_load_dwordx4 v5, s[8:11], s31 offen lds
    ds_read_b128 a[188:191], v1 offset:48128
    v_mfma_f32_16x16x32_bf16 v[52:55], v[28:31], a[152:155], v[52:55]
    v_mfma_f32_16x16x32_bf16 v[60:63], v[28:31], a[156:159], v[60:63]
    s_waitcnt vmcnt(15) lgkmcnt(6)
    v_mfma_f32_16x16x32_bf16 v[32:35], v[16:19], a[160:163], v[32:35]
    ds_read_b64_tr_b16 v[24:25], v3 offset:4096
    ds_read_b64_tr_b16 v[26:27], v3 offset:5120
    v_mfma_f32_16x16x32_bf16 v[40:43], v[16:19], a[164:167], v[40:43]
    buffer_load_dwordx4 v6, s[8:11], s31 offen offset:1024 lds
    ds_read_b128 a[192:195], v1 offset:49152
    v_mfma_f32_16x16x32_bf16 v[48:51], v[16:19], a[168:171], v[48:51]
    ds_read_b128 a[196:199], v1 offset:50176
    ds_read_b128 a[200:203], v1 offset:51200
    v_mfma_f32_16x16x32_bf16 v[56:59], v[16:19], a[172:175], v[56:59]
    s_add_u32 m0, s32, 2048
    s_add_u32 s31, s31, 294912
    s_waitcnt lgkmcnt(6)
    v_mfma_f32_16x16x32_bf16 v[36:39], v[20:23], a[160:163], v[36:39]
    ds_read_b64_tr_b16 v[28:29], v4 offset:4096
    ds_read_b64_tr_b16 v[30:31], v4 offset:5120
    v_mfma_f32_16x16x32_bf16 v[44:47], v[20:23], a[164:167], v[44:47]
    buffer_load_dwordx4 v5, s[8:11], s31 offen lds
    ds_read_b128 a[204:207], v1 offset:52224
    v_mfma_f32_16x16x32_bf16 v[52:55], v[20:23], a[168:171], v[52:55]
    v_mfma_f32_16x16x32_bf16 v[60:63], v[20:23], a[172:175], v[60:63]
    s_waitcnt vmcnt(14) lgkmcnt(6)
    v_mfma_f32_16x16x32_bf16 v[32:35], v[24:27], a[176:179], v[32:35]
    ds_read_b64_tr_b16 v[16:17], v3 offset:6144
    ds_read_b64_tr_b16 v[18:19], v3 offset:7168
    v_mfma_f32_16x16x32_bf16 v[40:43], v[24:27], a[180:183], v[40:43]
    buffer_load_dwordx4 v6, s[8:11], s31 offen offset:1024 lds
    ds_read_b128 a[208:211], v1 offset:53248
    v_mfma_f32_16x16x32_bf16 v[48:51], v[24:27], a[184:187], v[48:51]
    ds_read_b128 a[212:215], v1 offset:54272
    ds_read_b128 a[216:219], v1 offset:55296
    v_mfma_f32_16x16x32_bf16 v[56:59], v[24:27], a[188:191], v[56:59]
    s_add_u32 m0, s32, 4096
    s_add_u32 s31, s31, 294912
    s_waitcnt lgkmcnt(6)
    v_mfma_f32_16x16x32_bf16 v[36:39], v[28:31], a[176:179], v[36:39]
    ds_read_b64_tr_b16 v[20:21], v4 offset:6144
    ds_read_b64_tr_b16 v[22:23], v4 offset:7168
    v_mfma_f32_16x16x32_bf16 v[44:47], v[28:31], a[180:183], v[44:47]
    buffer_load_dwordx4 v5, s[8:11], s31 offen lds
    ds_read_b128 a[220:223], v1 offset:56320
    v_mfma_f32_16x16x32_bf16 v[52:55], v[28:31], a[184:187], v[52:55]
    v_mfma_f32_16x16x32_bf16 v[60:63], v[28:31], a[188:191], v[60:63]
    s_barrier
    s_waitcnt vmcnt(13) lgkmcnt(6)
    v_mfma_f32_16x16x32_bf16 v[32:35], v[16:19], a[192:195], v[32:35]
    ds_read_b64_tr_b16 v[24:25], v3 offset:8192
    ds_read_b64_tr_b16 v[26:27], v3 offset:9216
    ds_read_b128 a[224:227], v1 offset:57344
    v_mfma_f32_16x16x32_bf16 v[40:43], v[16:19], a[196:199], v[40:43]
    buffer_load_dwordx4 v6, s[8:11], s31 offen offset:1024 lds
    ds_read_b128 a[228:231], v1 offset:58368
    ds_read_b128 a[232:235], v1 offset:59392
    v_mfma_f32_16x16x32_bf16 v[48:51], v[16:19], a[200:203], v[48:51]
    ds_read_b128 a[236:239], v1 offset:60416
    s_lshl_b32 s36, s36, 1
    s_lshl_b32 s35, s34, 2
    v_mfma_f32_16x16x32_bf16 v[56:59], v[16:19], a[204:207], v[56:59]
    s_add_u32 m0, s32, 6144
    s_add_u32 s31, s31, 294912
    s_add_u32 s35, s35, s36
    s_waitcnt lgkmcnt(7)
    v_mfma_f32_16x16x32_bf16 v[36:39], v[20:23], a[192:195], v[36:39]
    ds_read_b64_tr_b16 v[28:29], v4 offset:8192
    ds_read_b64_tr_b16 v[30:31], v4 offset:9216
    s_lshl_b32 s35, s35, 10
    v_mfma_f32_16x16x32_bf16 v[44:47], v[20:23], a[196:199], v[44:47]
    buffer_load_dwordx4 v5, s[8:11], s31 offen lds
    s_add_u32 s35, s35, s58
    buffer_load_dwordx4 v[184:187], v1, s[16:19], s35 offen
    v_mfma_f32_16x16x32_bf16 v[52:55], v[20:23], a[200:203], v[52:55]
    s_lshl_b32 s35, s29, 2
    s_add_u32 s35, s35, s36
    s_mul_i32 s60, s35, 18432
    v_mfma_f32_16x16x32_bf16 v[60:63], v[20:23], a[204:207], v[60:63]
    s_lshl_b32 s37, s34, 6
    s_add_u32 s60, s60, s37
    s_waitcnt vmcnt(14) lgkmcnt(6)
    v_mfma_f32_16x16x32_bf16 v[32:35], v[24:27], a[208:211], v[32:35]
    ds_read_b64_tr_b16 v[16:17], v3 offset:10240
    ds_read_b64_tr_b16 v[18:19], v3 offset:11264
    ds_read_b128 a[240:243], v1 offset:61440
    v_mfma_f32_16x16x32_bf16 v[40:43], v[24:27], a[212:215], v[40:43]
    buffer_load_dwordx4 v6, s[8:11], s31 offen offset:1024 lds
    ds_read_b128 a[244:247], v1 offset:62464
    ds_read_b128 a[248:251], v1 offset:63488
    v_mfma_f32_16x16x32_bf16 v[48:51], v[24:27], a[216:219], v[48:51]
    ds_read_b128 a[252:255], v1 offset:64512
    s_lshl_b32 s37, s35, 6
    s_add_u32 s37, s37, 23650304
    v_mfma_f32_16x16x32_bf16 v[56:59], v[24:27], a[220:223], v[56:59]
    s_add_u32 m0, s32, 8192
    s_add_u32 s31, s31, 294912
    buffer_load_dword v204, v144, s[16:19], s37 offen
    s_waitcnt lgkmcnt(6)
    v_mfma_f32_16x16x32_bf16 v[36:39], v[28:31], a[208:211], v[36:39]
    ds_read_b64_tr_b16 v[20:21], v4 offset:10240
    ds_read_b64_tr_b16 v[22:23], v4 offset:11264
    s_lshl_b32 s37, s35, 10
    v_mfma_f32_16x16x32_bf16 v[44:47], v[28:31], a[212:215], v[44:47]
    buffer_load_dwordx4 v5, s[8:11], s31 offen lds
    s_add_u32 s37, s37, 23658496
    buffer_load_dwordx4 v[180:183], v145, s[16:19], s37 offen
    v_mfma_f32_16x16x32_bf16 v[52:55], v[28:31], a[216:219], v[52:55]
    s_lshl_b32 s37, s34, 15
    s_add_u32 s37, s37, s33
    s_lshl_b32 s35, s36, 10
    v_mfma_f32_16x16x32_bf16 v[60:63], v[28:31], a[220:223], v[60:63]
    s_add_u32 s59, s37, s35
    s_add_u32 s36, s36, 1
    s_waitcnt vmcnt(16) lgkmcnt(6)
    v_mfma_f32_16x16x32_bf16 v[32:35], v[16:19], a[224:227], v[32:35]
    ds_read_b64_tr_b16 v[24:25], v3 offset:12288
    ds_read_b64_tr_b16 v[26:27], v3 offset:13312
    ds_read_b128 v[112:115], v2 offset:0
    v_mfma_f32_16x16x32_bf16 v[40:43], v[16:19], a[228:231], v[40:43]
    buffer_load_dwordx4 v6, s[8:11], s31 offen offset:1024 lds
    ds_read_b128 v[116:119], v2 offset:1024
    ds_read_b128 v[120:123], v2 offset:2048
    v_mfma_f32_16x16x32_bf16 v[48:51], v[16:19], a[232:235], v[48:51]
    ds_read_b128 v[124:127], v2 offset:3072
    s_lshl_b32 s35, s34, 2
    s_add_u32 s35, s35, s36
    v_mfma_f32_16x16x32_bf16 v[56:59], v[16:19], a[236:239], v[56:59]
    s_add_u32 m0, s32, 10240
    s_add_u32 s31, s31, 294912
    s_lshl_b32 s35, s35, 10
    s_waitcnt lgkmcnt(6)
    v_mfma_f32_16x16x32_bf16 v[36:39], v[20:23], a[224:227], v[36:39]
    ds_read_b64_tr_b16 v[28:29], v4 offset:12288
    ds_read_b64_tr_b16 v[30:31], v4 offset:13312
    s_add_u32 s35, s35, s58
    v_mfma_f32_16x16x32_bf16 v[44:47], v[20:23], a[228:231], v[44:47]
    buffer_load_dwordx4 v5, s[8:11], s31 offen lds
    buffer_load_dwordx4 v[192:195], v1, s[16:19], s35 offen
    s_lshl_b32 s35, s29, 2
    v_mfma_f32_16x16x32_bf16 v[52:55], v[20:23], a[232:235], v[52:55]
    s_add_u32 s35, s35, s36
    s_mul_i32 s62, s35, 18432
    s_lshl_b32 s37, s34, 6
    v_mfma_f32_16x16x32_bf16 v[60:63], v[20:23], a[236:239], v[60:63]
    s_add_u32 s62, s62, s37
    s_lshl_b32 s37, s35, 6
    s_barrier
    s_waitcnt vmcnt(17) lgkmcnt(6)
    v_mfma_f32_16x16x32_bf16 v[32:35], v[24:27], a[240:243], v[32:35]
    ds_read_b64_tr_b16 v[16:17], v3 offset:14336
    ds_read_b64_tr_b16 v[18:19], v3 offset:15360
    ds_read_b128 v[128:131], v2 offset:4096
    v_mfma_f32_16x16x32_bf16 v[40:43], v[24:27], a[244:247], v[40:43]
    buffer_load_dwordx4 v6, s[8:11], s31 offen offset:1024 lds
    ds_read_b128 v[132:135], v2 offset:5120
    ds_read_b128 v[136:139], v2 offset:6144
    v_mfma_f32_16x16x32_bf16 v[48:51], v[24:27], a[248:251], v[48:51]
    ds_read_b128 v[140:143], v2 offset:7168
    s_add_u32 s37, s37, 23650304
    buffer_load_dword v205, v144, s[16:19], s37 offen
    v_mfma_f32_16x16x32_bf16 v[56:59], v[24:27], a[252:255], v[56:59]
    s_add_u32 m0, s32, 12288
    s_add_u32 s31, s31, 294912
    s_lshl_b32 s37, s35, 10
    s_waitcnt lgkmcnt(6)
    v_mfma_f32_16x16x32_bf16 v[36:39], v[28:31], a[240:243], v[36:39]
    ds_read_b64_tr_b16 v[20:21], v4 offset:14336
    ds_read_b64_tr_b16 v[22:23], v4 offset:15360
    s_add_u32 s37, s37, 23658496
    v_mfma_f32_16x16x32_bf16 v[44:47], v[28:31], a[244:247], v[44:47]
    buffer_load_dwordx4 v5, s[8:11], s31 offen lds
    buffer_load_dwordx4 v[188:191], v145, s[16:19], s37 offen
    s_lshl_b32 s37, s34, 15
    v_mfma_f32_16x16x32_bf16 v[52:55], v[28:31], a[248:251], v[52:55]
    s_add_u32 s37, s37, s33
    s_lshl_b32 s35, s36, 10
    s_add_u32 s61, s37, s35
    v_mfma_f32_16x16x32_bf16 v[60:63], v[28:31], a[252:255], v[60:63]
    s_lshr_b32 s34, s28, 2
    s_add_u32 s34, s34, 16
    s_waitcnt vmcnt(19) lgkmcnt(6)
    v_mfma_f32_16x16x32_bf16 v[32:35], v[16:19], v[112:115], v[32:35]
    ds_read_b64_tr_b16 v[24:25], v3 offset:16384
    ds_read_b64_tr_b16 v[26:27], v3 offset:17408
    s_and_b32 s36, s28, 3
    v_mfma_f32_16x16x32_bf16 v[40:43], v[16:19], v[116:119], v[40:43]
    buffer_load_dwordx4 v6, s[8:11], s31 offen offset:1024 lds
    s_lshl_b32 s35, s34, 2
    s_add_u32 s35, s35, s36
    v_mfma_f32_16x16x32_bf16 v[48:51], v[16:19], v[120:123], v[48:51]
    s_lshl_b32 s35, s35, 10
    s_add_u32 s35, s35, s58
    buffer_load_dwordx4 v[200:203], v1, s[16:19], s35 offen
    v_mfma_f32_16x16x32_bf16 v[56:59], v[16:19], v[124:127], v[56:59]
    s_add_u32 m0, s32, 14336
    s_add_u32 s31, s31, 294912
    s_lshl_b32 s35, s29, 2
    s_waitcnt lgkmcnt(2)
    v_mfma_f32_16x16x32_bf16 v[36:39], v[20:23], v[112:115], v[36:39]
    ds_read_b64_tr_b16 v[28:29], v4 offset:16384
    ds_read_b64_tr_b16 v[30:31], v4 offset:17408
    s_add_u32 s35, s35, s36
    v_mfma_f32_16x16x32_bf16 v[44:47], v[20:23], v[116:119], v[44:47]
    buffer_load_dwordx4 v5, s[8:11], s31 offen lds
    s_mul_i32 s64, s35, 18432
    s_lshl_b32 s37, s34, 6
    v_mfma_f32_16x16x32_bf16 v[52:55], v[20:23], v[120:123], v[52:55]
    s_add_u32 s64, s64, s37
    v_mfma_f32_16x16x32_bf16 v[60:63], v[20:23], v[124:127], v[60:63]
    s_waitcnt vmcnt(20) lgkmcnt(2)
    v_mfma_f32_16x16x32_bf16 v[32:35], v[24:27], v[128:131], v[32:35]
    ds_read_b64_tr_b16 v[16:17], v3 offset:0
    ds_read_b64_tr_b16 v[18:19], v3 offset:1024
    s_lshl_b32 s37, s35, 6
    v_mfma_f32_16x16x32_bf16 v[40:43], v[24:27], v[132:135], v[40:43]
    buffer_load_dwordx4 v6, s[8:11], s31 offen offset:1024 lds
    s_add_u32 s37, s37, 23650304
    buffer_load_dword v206, v144, s[16:19], s37 offen
    v_mfma_f32_16x16x32_bf16 v[48:51], v[24:27], v[136:139], v[48:51]
    s_lshl_b32 s37, s35, 10
    s_add_u32 s37, s37, 23658496
    buffer_load_dwordx4 v[196:199], v145, s[16:19], s37 offen
    v_mfma_f32_16x16x32_bf16 v[56:59], v[24:27], v[140:143], v[56:59]
    s_add_u32 m0, s32, 16384
    s_add_u32 s31, s31, 294912
    s_lshl_b32 s37, s34, 15
    s_waitcnt lgkmcnt(2)
    v_mfma_f32_16x16x32_bf16 v[36:39], v[28:31], v[128:131], v[36:39]
    ds_read_b64_tr_b16 v[20:21], v4 offset:0
    ds_read_b64_tr_b16 v[22:23], v4 offset:1024
    s_add_u32 s37, s37, s33
    v_mfma_f32_16x16x32_bf16 v[44:47], v[28:31], v[132:135], v[44:47]
    buffer_load_dwordx4 v5, s[8:11], s31 offen lds
    s_lshl_b32 s35, s36, 10
    s_add_u32 s63, s37, s35
    v_mfma_f32_16x16x32_bf16 v[52:55], v[28:31], v[136:139], v[52:55]
    v_mfma_f32_16x16x32_bf16 v[60:63], v[28:31], v[140:143], v[60:63]
    s_barrier
    s_mov_b32 s38, 2
L_strip_33:
    s_waitcnt vmcnt(13) lgkmcnt(2)
    v_cvt_pk_bf16_f32 v96, v32, v33
    v_cvt_pk_bf16_f32 v97, v34, v35
    v_cvt_pk_bf16_f32 v98, v36, v37
    v_cvt_pk_bf16_f32 v99, v38, v39
    v_mfma_f32_16x16x32_bf16 v[32:35], v[16:19], a[0:3], 0
    ds_read_b64_tr_b16 v[24:25], v3 offset:2048
    ds_read_b64_tr_b16 v[26:27], v3 offset:3072
    v_cvt_pk_bf16_f32 v100, v40, v41
    v_cvt_pk_bf16_f32 v101, v42, v43
    v_cvt_pk_bf16_f32 v102, v44, v45
    v_cvt_pk_bf16_f32 v103, v46, v47
    v_mfma_f32_16x16x32_bf16 v[40:43], v[16:19], a[4:7], 0
    buffer_load_dwordx4 v6, s[8:11], s31 offen offset:1024 lds
    v_cvt_pk_bf16_f32 v104, v48, v49
    v_cvt_pk_bf16_f32 v105, v50, v51
    v_cvt_pk_bf16_f32 v106, v52, v53
    v_cvt_pk_bf16_f32 v107, v54, v55
    v_mfma_f32_16x16x32_bf16 v[48:51], v[16:19], a[8:11], 0
    v_cvt_pk_bf16_f32 v108, v56, v57
    v_cvt_pk_bf16_f32 v109, v58, v59
    v_cvt_pk_bf16_f32 v110, v60, v61
    v_cvt_pk_bf16_f32 v111, v62, v63
    v_mfma_f32_16x16x32_bf16 v[56:59], v[16:19], a[12:15], 0
    s_add_u32 m0, s32, 0
    s_add_u32 s31, s31, 294912
    s_waitcnt lgkmcnt(2)
    v_mfma_f32_16x16x32_bf16 v[36:39], v[20:23], a[0:3], 0
    ds_read_b64_tr_b16 v[28:29], v4 offset:2048
    ds_read_b64_tr_b16 v[30:31], v4 offset:3072
    v_mfma_f32_16x16x32_bf16 v[44:47], v[20:23], a[4:7], 0
    buffer_load_dwordx4 v5, s[8:11], s31 offen lds
    v_mfma_f32_16x16x32_bf16 v[52:55], v[20:23], a[8:11], 0
    v_mfma_f32_16x16x32_bf16 v[60:63], v[20:23], a[12:15], 0
    s_waitcnt vmcnt(13) lgkmcnt(2)
    v_mfma_f32_16x16x32_bf16 v[32:35], v[24:27], a[16:19], v[32:35]
    ds_read_b64_tr_b16 v[16:17], v3 offset:4096
    ds_read_b64_tr_b16 v[18:19], v3 offset:5120
    v_add_u32 v9, s50, v1
    v_mfma_f32_16x16x32_bf16 v[40:43], v[24:27], a[20:23], v[40:43]
    buffer_load_dwordx4 v6, s[8:11], s31 offen offset:1024 lds
    v_pk_max_i16 v96, v96, 0
    v_pk_max_i16 v97, v97, 0
    v_mfma_f32_16x16x32_bf16 v[48:51], v[24:27], a[24:27], v[48:51]
    v_pk_max_i16 v98, v98, 0
    v_pk_max_i16 v99, v99, 0
    ds_write_b128 v9, v[96:99] offset:0
    v_mfma_f32_16x16x32_bf16 v[56:59], v[24:27], a[28:31], v[56:59]
    s_add_u32 m0, s32, 2048
    s_add_u32 s31, s31, 294912
    v_pk_max_i16 v100, v100, 0
    s_waitcnt lgkmcnt(3)
    v_mfma_f32_16x16x32_bf16 v[36:39], v[28:31], a[16:19], v[36:39]
    ds_read_b64_tr_b16 v[20:21], v4 offset:4096
    ds_read_b64_tr_b16 v[22:23], v4 offset:5120
    v_pk_max_i16 v101, v101, 0
    v_mfma_f32_16x16x32_bf16 v[44:47], v[28:31], a[20:23], v[44:47]
    buffer_load_dwordx4 v5, s[8:11], s31 offen lds
    v_pk_max_i16 v102, v102, 0
    v_pk_max_i16 v103, v103, 0
    v_mfma_f32_16x16x32_bf16 v[52:55], v[28:31], a[24:27], v[52:55]
    ds_write_b128 v9, v[100:103] offset:1024
    v_mfma_f32_16x16x32_bf16 v[60:63], v[28:31], a[28:31], v[60:63]
    s_waitcnt vmcnt(13) lgkmcnt(4)
    v_mfma_f32_16x16x32_bf16 v[32:35], v[16:19], a[32:35], v[32:35]
    ds_read_b64_tr_b16 v[24:25], v3 offset:6144
    ds_read_b64_tr_b16 v[26:27], v3 offset:7168
    v_pk_max_i16 v104, v104, 0
    v_mfma_f32_16x16x32_bf16 v[40:43], v[16:19], a[36:39], v[40:43]
    buffer_load_dwordx4 v6, s[8:11], s31 offen offset:1024 lds
    v_pk_max_i16 v105, v105, 0
    v_pk_max_i16 v106, v106, 0
    v_mfma_f32_16x16x32_bf16 v[48:51], v[16:19], a[40:43], v[48:51]
    v_pk_max_i16 v107, v107, 0
    ds_write_b128 v9, v[104:107] offset:2048
    v_pk_max_i16 v108, v108, 0
    v_mfma_f32_16x16x32_bf16 v[56:59], v[16:19], a[44:47], v[56:59]
    s_add_u32 m0, s32, 4096
    s_add_u32 s31, s31, 294912
    v_pk_max_i16 v109, v109, 0
    s_waitcnt lgkmcnt(4)
    v_mfma_f32_16x16x32_bf16 v[36:39], v[20:23], a[32:35], v[36:39]
    ds_read_b64_tr_b16 v[28:29], v4 offset:6144
    ds_read_b64_tr_b16 v[30:31], v4 offset:7168
    v_pk_max_i16 v110, v110, 0
    v_mfma_f32_16x16x32_bf16 v[44:47], v[20:23], a[36:39], v[44:47]
    buffer_load_dwordx4 v5, s[8:11], s31 offen lds
    v_pk_max_i16 v111, v111, 0
    ds_write_b128 v9, v[108:111] offset:3072
    v_mfma_f32_16x16x32_bf16 v[52:55], v[20:23], a[40:43], v[52:55]
    v_mfma_f32_16x16x32_bf16 v[60:63], v[20:23], a[44:47], v[60:63]
    s_waitcnt vmcnt(13) lgkmcnt(4)
    v_mfma_f32_16x16x32_bf16 v[32:35], v[24:27], a[48:51], v[32:35]
    ds_read_b64_tr_b16 v[16:17], v3 offset:8192
    ds_read_b64_tr_b16 v[18:19], v3 offset:9216
    v_mfma_f32_16x16x32_bf16 v[40:43], v[24:27], a[52:55], v[40:43]
    buffer_load_dwordx4 v6, s[8:11], s31 offen offset:1024 lds
    v_mfma_f32_16x16x32_bf16 v[48:51], v[24:27], a[56:59], v[48:51]
    v_mfma_f32_16x16x32_bf16 v[56:59], v[24:27], a[60:63], v[56:59]
    s_add_u32 m0, s32, 6144
    s_add_u32 s31, s31, 294912
    s_waitcnt lgkmcnt(3)
    v_mfma_f32_16x16x32_bf16 v[36:39], v[28:31], a[48:51], v[36:39]
    ds_read_b64_tr_b16 v[20:21], v4 offset:8192
    ds_read_b64_tr_b16 v[22:23], v4 offset:9216
    v_mfma_f32_16x16x32_bf16 v[44:47], v[28:31], a[52:55], v[44:47]
    buffer_load_dwordx4 v5, s[8:11], s31 offen lds
    v_mfma_f32_16x16x32_bf16 v[52:55], v[28:31], a[56:59], v[52:55]
    v_mfma_f32_16x16x32_bf16 v[60:63], v[28:31], a[60:63], v[60:63]
    s_waitcnt vmcnt(13) lgkmcnt(2)
    v_mfma_f32_16x16x32_bf16 v[32:35], v[16:19], a[64:67], v[32:35]
    ds_read_b64_tr_b16 v[24:25], v3 offset:10240
    ds_read_b64_tr_b16 v[26:27], v3 offset:11264
    v_mfma_f32_16x16x32_bf16 v[40:43], v[16:19], a[68:71], v[40:43]
    buffer_load_dwordx4 v6, s[8:11], s31 offen offset:1024 lds
    v_mfma_f32_16x16x32_bf16 v[48:51], v[16:19], a[72:75], v[48:51]
    v_mfma_f32_16x16x32_bf16 v[56:59], v[16:19], a[76:79], v[56:59]
    s_add_u32 m0, s32, 8192
    s_add_u32 s31, s31, 294912
    s_waitcnt lgkmcnt(2)
    v_mfma_f32_16x16x32_bf16 v[36:39], v[20:23], a[64:67], v[36:39]
    ds_read_b64_tr_b16 v[28:29], v4 offset:10240
    ds_read_b64_tr_b16 v[30:31], v4 offset:11264
    v_mfma_f32_16x16x32_bf16 v[44:47], v[20:23], a[68:71], v[44:47]
    buffer_load_dwordx4 v5, s[8:11], s31 offen lds
    v_mfma_f32_16x16x32_bf16 v[52:55], v[20:23], a[72:75], v[52:55]
    v_mfma_f32_16x16x32_bf16 v[60:63], v[20:23], a[76:79], v[60:63]
    s_waitcnt vmcnt(13) lgkmcnt(2)
    v_mfma_f32_16x16x32_bf16 v[32:35], v[24:27], a[80:83], v[32:35]
    ds_read_b64_tr_b16 v[16:17], v3 offset:12288
    ds_read_b64_tr_b16 v[18:19], v3 offset:13312
    v_mfma_f32_16x16x32_bf16 v[40:43], v[24:27], a[84:87], v[40:43]
    buffer_load_dwordx4 v6, s[8:11], s31 offen offset:1024 lds
    v_mfma_f32_16x16x32_bf16 v[48:51], v[24:27], a[88:91], v[48:51]
    v_mfma_f32_16x16x32_bf16 v[56:59], v[24:27], a[92:95], v[56:59]
    s_add_u32 m0, s32, 10240
    s_add_u32 s31, s31, 294912
    s_waitcnt lgkmcnt(2)
    v_mfma_f32_16x16x32_bf16 v[36:39], v[28:31], a[80:83], v[36:39]
    ds_read_b64_tr_b16 v[20:21], v4 offset:12288
    ds_read_b64_tr_b16 v[22:23], v4 offset:13312
    v_mfma_f32_16x16x32_bf16 v[44:47], v[28:31], a[84:87], v[44:47]
    buffer_load_dwordx4 v5, s[8:11], s31 offen lds
    v_mfma_f32_16x16x32_bf16 v[52:55], v[28:31], a[88:91], v[52:55]
    v_mfma_f32_16x16x32_bf16 v[60:63], v[28:31], a[92:95], v[60:63]
    s_waitcnt vmcnt(13) lgkmcnt(2)
    v_mfma_f32_16x16x32_bf16 v[32:35], v[16:19], a[96:99], v[32:35]
    ds_read_b64_tr_b16 v[24:25], v3 offset:14336
    ds_read_b64_tr_b16 v[26:27], v3 offset:15360
    v_mfma_f32_16x16x32_bf16 v[40:43], v[16:19], a[100:103], v[40:43]
    buffer_load_dwordx4 v6, s[8:11], s31 offen offset:1024 lds
    v_mfma_f32_16x16x32_bf16 v[48:51], v[16:19], a[104:107], v[48:51]
    v_mfma_f32_16x16x32_bf16 v[56:59], v[16:19], a[108:111], v[56:59]
    s_add_u32 m0, s32, 12288
    s_add_u32 s31, s31, 294912
    s_waitcnt lgkmcnt(2)
    v_mfma_f32_16x16x32_bf16 v[36:39], v[20:23], a[96:99], v[36:39]
    ds_read_b64_tr_b16 v[28:29], v4 offset:14336
    ds_read_b64_tr_b16 v[30:31], v4 offset:15360
    v_mfma_f32_16x16x32_bf16 v[44:47], v[20:23], a[100:103], v[44:47]
    buffer_load_dwordx4 v5, s[8:11], s31 offen lds
    v_mfma_f32_16x16x32_bf16 v[52:55], v[20:23], a[104:107], v[52:55]
    v_mfma_f32_16x16x32_bf16 v[60:63], v[20:23], a[108:111], v[60:63]
    s_waitcnt vmcnt(13) lgkmcnt(2)
    v_mfma_f32_16x16x32_bf16 v[32:35], v[24:27], a[112:115], v[32:35]
    ds_read_b64_tr_b16 v[16:17], v3 offset:16384
    ds_read_b64_tr_b16 v[18:19], v3 offset:17408
    v_mfma_f32_16x16x32_bf16 v[40:43], v[24:27], a[116:119], v[40:43]
    buffer_load_dwordx4 v6, s[8:11], s31 offen offset:1024 lds
    v_mfma_f32_16x16x32_bf16 v[48:51], v[24:27], a[120:123], v[48:51]
    v_mfma_f32_16x16x32_bf16 v[56:59], v[24:27], a[124:127], v[56:59]
    s_add_u32 m0, s32, 14336
    s_add_u32 s31, s31, 294912
    s_waitcnt lgkmcnt(2)
    v_mfma_f32_16x16x32_bf16 v[36:39], v[28:31], a[112:115], v[36:39]
    ds_read_b64_tr_b16 v[20:21], v4 offset:16384
    ds_read_b64_tr_b16 v[22:23], v4 offset:17408
    v_mfma_f32_16x16x32_bf16 v[44:47], v[28:31], a[116:119], v[44:47]
    buffer_load_dwordx4 v5, s[8:11], s31 offen lds
    v_mfma_f32_16x16x32_bf16 v[52:55], v[28:31], a[120:123], v[52:55]
    v_mfma_f32_16x16x32_bf16 v[60:63], v[28:31], a[124:127], v[60:63]
    s_waitcnt vmcnt(13) lgkmcnt(2)
    v_mfma_f32_16x16x32_bf16 v[32:35], v[16:19], a[128:131], v[32:35]
    ds_read_b64_tr_b16 v[24:25], v3 offset:0
    ds_read_b64_tr_b16 v[26:27], v3 offset:1024
    v_mfma_f32_16x16x32_bf16 v[40:43], v[16:19], a[132:135], v[40:43]
    buffer_load_dwordx4 v6, s[8:11], s31 offen offset:1024 lds
    v_mfma_f32_16x16x32_bf16 v[48:51], v[16:19], a[136:139], v[48:51]
    v_mfma_f32_16x16x32_bf16 v[56:59], v[16:19], a[140:143], v[56:59]
    s_add_u32 m0, s32, 16384
    s_add_u32 s31, s31, 294912
    s_waitcnt lgkmcnt(2)
    v_mfma_f32_16x16x32_bf16 v[36:39], v[20:23], a[128:131], v[36:39]
    ds_read_b64_tr_b16 v[28:29], v4 offset:0
    ds_read_b64_tr_b16 v[30:31], v4 offset:1024
    v_mfma_f32_16x16x32_bf16 v[44:47], v[20:23], a[132:135], v[44:47]
    buffer_load_dwordx4 v5, s[8:11], s31 offen lds
    v_mfma_f32_16x16x32_bf16 v[52:55], v[20:23], a[136:139], v[52:55]
    v_mfma_f32_16x16x32_bf16 v[60:63], v[20:23], a[140:143], v[60:63]
    s_waitcnt vmcnt(13) lgkmcnt(2)
    v_mfma_f32_16x16x32_bf16 v[32:35], v[24:27], a[144:147], v[32:35]
    ds_read_b64_tr_b16 v[16:17], v3 offset:2048
    ds_read_b64_tr_b16 v[18:19], v3 offset:3072
    v_mfma_f32_16x16x32_bf16 v[40:43], v[24:27], a[148:151], v[40:43]
    buffer_load_dwordx4 v6, s[8:11], s31 offen offset:1024 lds
    v_mfma_f32_16x16x32_bf16 v[48:51], v[24:27], a[152:155], v[48:51]
    v_mfma_f32_16x16x32_bf16 v[56:59], v[24:27], a[156:159], v[56:59]
    s_add_u32 m0, s32, 0
    s_mov_b32 s31, s42
    s_waitcnt lgkmcnt(2)
    v_mfma_f32_16x16x32_bf16 v[36:39], v[28:31], a[144:147], v[36:39]
    ds_read_b64_tr_b16 v[20:21], v4 offset:2048
    ds_read_b64_tr_b16 v[22:23], v4 offset:3072
    v_mfma_f32_16x16x32_bf16 v[44:47], v[28:31], a[148:151], v[44:47]
    buffer_load_dwordx4 v5, s[8:11], s31 offen lds
    v_mfma_f32_16x16x32_bf16 v[52:55], v[28:31], a[152:155], v[52:55]
    v_mfma_f32_16x16x32_bf16 v[60:63], v[28:31], a[156:159], v[60:63]
    s_waitcnt vmcnt(13) lgkmcnt(2)
    v_mfma_f32_16x16x32_bf16 v[32:35], v[16:19], a[160:163], v[32:35]
    ds_read_b64_tr_b16 v[24:25], v3 offset:4096
    ds_read_b64_tr_b16 v[26:27], v3 offset:5120
    v_mfma_f32_16x16x32_bf16 v[40:43], v[16:19], a[164:167], v[40:43]
    buffer_load_dwordx4 v6, s[8:11], s31 offen offset:1024 lds
    v_mfma_f32_16x16x32_bf16 v[48:51], v[16:19], a[168:171], v[48:51]
    v_mfma_f32_16x16x32_bf16 v[56:59], v[16:19], a[172:175], v[56:59]
    s_add_u32 m0, s32, 2048
    s_add_u32 s31, s31, 294912
    s_waitcnt lgkmcnt(2)
    v_mfma_f32_16x16x32_bf16 v[36:39], v[20:23], a[160:163], v[36:39]
    ds_read_b64_tr_b16 v[28:29], v4 offset:4096
    ds_read_b64_tr_b16 v[30:31], v4 offset:5120
    v_mfma_f32_16x16x32_bf16 v[44:47], v[20:23], a[164:167], v[44:47]
    buffer_load_dwordx4 v5, s[8:11], s31 offen lds
    v_mfma_f32_16x16x32_bf16 v[52:55], v[20:23], a[168:171], v[52:55]
    v_mfma_f32_16x16x32_bf16 v[60:63], v[20:23], a[172:175], v[60:63]
    s_waitcnt vmcnt(13) lgkmcnt(2)
    v_mfma_f32_16x16x32_bf16 v[32:35], v[24:27], a[176:179], v[32:35]
    ds_read_b64_tr_b16 v[16:17], v3 offset:6144
    ds_read_b64_tr_b16 v[18:19], v3 offset:7168
    v_mfma_f32_16x16x32_bf16 v[40:43], v[24:27], a[180:183], v[40:43]
    buffer_load_dwordx4 v6, s[8:11], s31 offen offset:1024 lds
    v_mfma_f32_16x16x32_bf16 v[48:51], v[24:27], a[184:187], v[48:51]
    v_mfma_f32_16x16x32_bf16 v[56:59], v[24:27], a[188:191], v[56:59]
    s_add_u32 m0, s32, 4096
    s_add_u32 s31, s31, 294912
    s_waitcnt lgkmcnt(2)
    v_mfma_f32_16x16x32_bf16 v[36:39], v[28:31], a[176:179], v[36:39]
    ds_read_b64_tr_b16 v[20:21], v4 offset:6144
    ds_read_b64_tr_b16 v[22:23], v4 offset:7168
    v_mfma_f32_16x16x32_bf16 v[44:47], v[28:31], a[180:183], v[44:47]
    buffer_load_dwordx4 v5, s[8:11], s31 offen lds
    v_mfma_f32_16x16x32_bf16 v[52:55], v[28:31], a[184:187], v[52:55]
    v_mfma_f32_16x16x32_bf16 v[60:63], v[28:31], a[188:191], v[60:63]
    s_waitcnt vmcnt(13) lgkmcnt(2)
    v_mfma_f32_16x16x32_bf16 v[32:35], v[16:19], a[192:195], v[32:35]
    ds_read_b64_tr_b16 v[24:25], v3 offset:8192
    ds_read_b64_tr_b16 v[26:27], v3 offset:9216
    v_mfma_f32_16x16x32_bf16 v[40:43], v[16:19], a[196:199], v[40:43]
    buffer_load_dwordx4 v6, s[8:11], s31 offen offset:1024 lds
    v_mfma_f32_16x16x32_bf16 v[48:51], v[16:19], a[200:203], v[48:51]
    v_mfma_f32_16x16x32_bf16 v[56:59], v[16:19], a[204:207], v[56:59]
    s_add_u32 m0, s32, 6144
    s_add_u32 s31, s31, 294912
    s_waitcnt lgkmcnt(2)
    v_mfma_f32_16x16x32_bf16 v[36:39], v[20:23], a[192:195], v[36:39]
    ds_read_b64_tr_b16 v[28:29], v4 offset:8192
    ds_read_b64_tr_b16 v[30:31], v4 offset:9216
    v_mfma_f32_16x16x32_bf16 v[44:47], v[20:23], a[196:199], v[44:47]
    buffer_load_dwordx4 v5, s[8:11], s31 offen lds
    v_mfma_f32_16x16x32_bf16 v[52:55], v[20:23], a[200:203], v[52:55]
    v_mfma_f32_16x16x32_bf16 v[60:63], v[20:23], a[204:207], v[60:63]
    s_waitcnt vmcnt(13) lgkmcnt(2)
    v_mfma_f32_16x16x32_bf16 v[32:35], v[24:27], a[208:211], v[32:35]
    ds_read_b64_tr_b16 v[16:17], v3 offset:10240
    ds_read_b64_tr_b16 v[18:19], v3 offset:11264
    v_mfma_f32_16x16x32_bf16 v[40:43], v[24:27], a[212:215], v[40:43]
    buffer_load_dwordx4 v6, s[8:11], s31 offen offset:1024 lds
    v_mfma_f32_16x16x32_bf16 v[48:51], v[24:27], a[216:219], v[48:51]
    v_mfma_f32_16x16x32_bf16 v[56:59], v[24:27], a[220:223], v[56:59]
    s_add_u32 m0, s32, 8192
    s_add_u32 s31, s31, 294912
    s_waitcnt lgkmcnt(2)
    v_mfma_f32_16x16x32_bf16 v[36:39], v[28:31], a[208:211], v[36:39]
    ds_read_b64_tr_b16 v[20:21], v4 offset:10240
    ds_read_b64_tr_b16 v[22:23], v4 offset:11264
    v_mfma_f32_16x16x32_bf16 v[44:47], v[28:31], a[212:215], v[44:47]
    buffer_load_dwordx4 v5, s[8:11], s31 offen lds
    v_mfma_f32_16x16x32_bf16 v[52:55], v[28:31], a[216:219], v[52:55]
    v_mfma_f32_16x16x32_bf16 v[60:63], v[28:31], a[220:223], v[60:63]
    s_waitcnt vmcnt(13) lgkmcnt(2)
    v_mfma_f32_16x16x32_bf16 v[32:35], v[16:19], a[224:227], v[32:35]
    ds_read_b64_tr_b16 v[24:25], v3 offset:12288
    ds_read_b64_tr_b16 v[26:27], v3 offset:13312
    v_mfma_f32_16x16x32_bf16 v[40:43], v[16:19], a[228:231], v[40:43]
    buffer_load_dwordx4 v6, s[8:11], s31 offen offset:1024 lds
    s_mov_b32 s42, s43
    v_mfma_f32_16x16x32_bf16 v[48:51], v[16:19], a[232:235], v[48:51]
    s_mov_b32 s43, s44
    s_mov_b32 s50, s51
    v_mfma_f32_16x16x32_bf16 v[56:59], v[16:19], a[236:239], v[56:59]
    s_add_u32 m0, s32, 10240
    s_add_u32 s31, s31, 294912
    s_waitcnt lgkmcnt(2)
    v_mfma_f32_16x16x32_bf16 v[36:39], v[20:23], a[224:227], v[36:39]
    ds_read_b64_tr_b16 v[28:29], v4 offset:12288
    ds_read_b64_tr_b16 v[30:31], v4 offset:13312
    v_mfma_f32_16x16x32_bf16 v[44:47], v[20:23], a[228:231], v[44:47]
    buffer_load_dwordx4 v5, s[8:11], s31 offen lds
    s_mov_b32 s51, s52
    v_mfma_f32_16x16x32_bf16 v[52:55], v[20:23], a[232:235], v[52:55]
    s_mov_b32 s52, s53
    v_mfma_f32_16x16x32_bf16 v[60:63], v[20:23], a[236:239], v[60:63]
    s_waitcnt vmcnt(13) lgkmcnt(2)
    v_mfma_f32_16x16x32_bf16 v[32:35], v[24:27], a[240:243], v[32:35]
    ds_read_b64_tr_b16 v[16:17], v3 offset:14336
    ds_read_b64_tr_b16 v[18:19], v3 offset:15360
    v_mfma_f32_16x16x32_bf16 v[40:43], v[24:27], a[244:247], v[40:43]
    buffer_load_dwordx4 v6, s[8:11], s31 offen offset:1024 lds
    v_mfma_f32_16x16x32_bf16 v[48:51], v[24:27], a[248:251], v[48:51]
    v_mfma_f32_16x16x32_bf16 v[56:59], v[24:27], a[252:255], v[56:59]
    s_add_u32 m0, s32, 12288
    s_add_u32 s31, s31, 294912
    s_waitcnt lgkmcnt(2)
    v_mfma_f32_16x16x32_bf16 v[36:39], v[28:31], a[240:243], v[36:39]
    ds_read_b64_tr_b16 v[20:21], v4 offset:14336
    ds_read_b64_tr_b16 v[22:23], v4 offset:15360
    v_mfma_f32_16x16x32_bf16 v[44:47], v[28:31], a[244:247], v[44:47]
    buffer_load_dwordx4 v5, s[8:11], s31 offen lds
    v_mfma_f32_16x16x32_bf16 v[52:55], v[28:31], a[248:251], v[52:55]
    v_mfma_f32_16x16x32_bf16 v[60:63], v[28:31], a[252:255], v[60:63]
    s_waitcnt vmcnt(13) lgkmcnt(2)
    v_mfma_f32_16x16x32_bf16 v[32:35], v[16:19], v[112:115], v[32:35]
    ds_read_b64_tr_b16 v[24:25], v3 offset:16384
    ds_read_b64_tr_b16 v[26:27], v3 offset:17408
    v_mfma_f32_16x16x32_bf16 v[40:43], v[16:19], v[116:119], v[40:43]
    buffer_load_dwordx4 v6, s[8:11], s31 offen offset:1024 lds
    v_mfma_f32_16x16x32_bf16 v[48:51], v[16:19], v[120:123], v[48:51]
    v_mfma_f32_16x16x32_bf16 v[56:59], v[16:19], v[124:127], v[56:59]
    s_add_u32 m0, s32, 14336
    s_add_u32 s31, s31, 294912
    s_waitcnt lgkmcnt(2)
    v_mfma_f32_16x16x32_bf16 v[36:39], v[20:23], v[112:115], v[36:39]
    ds_read_b64_tr_b16 v[28:29], v4 offset:16384
    ds_read_b64_tr_b16 v[30:31], v4 offset:17408
    v_mfma_f32_16x16x32_bf16 v[44:47], v[20:23], v[116:119], v[44:47]
    buffer_load_dwordx4 v5, s[8:11], s31 offen lds
    v_mfma_f32_16x16x32_bf16 v[52:55], v[20:23], v[120:123], v[52:55]
    v_mfma_f32_16x16x32_bf16 v[60:63], v[20:23], v[124:127], v[60:63]
    s_waitcnt vmcnt(13) lgkmcnt(2)
    v_mfma_f32_16x16x32_bf16 v[32:35], v[24:27], v[128:131], v[32:35]
    ds_read_b64_tr_b16 v[16:17], v3 offset:0
    ds_read_b64_tr_b16 v[18:19], v3 offset:1024
    v_mfma_f32_16x16x32_bf16 v[40:43], v[24:27], v[132:135], v[40:43]
    buffer_load_dwordx4 v6, s[8:11], s31 offen offset:1024 lds
    v_mfma_f32_16x16x32_bf16 v[48:51], v[24:27], v[136:139], v[48:51]
    v_mfma_f32_16x16x32_bf16 v[56:59], v[24:27], v[140:143], v[56:59]
    s_add_u32 m0, s32, 16384
    s_add_u32 s31, s31, 294912
    s_waitcnt lgkmcnt(2)
    v_mfma_f32_16x16x32_bf16 v[36:39], v[28:31], v[128:131], v[36:39]
    ds_read_b64_tr_b16 v[20:21], v4 offset:0
    ds_read_b64_tr_b16 v[22:23], v4 offset:1024
    v_mfma_f32_16x16x32_bf16 v[44:47], v[28:31], v[132:135], v[44:47]
    buffer_load_dwordx4 v5, s[8:11], s31 offen lds
    v_mfma_f32_16x16x32_bf16 v[52:55], v[28:31], v[136:139], v[52:55]
    v_mfma_f32_16x16x32_bf16 v[60:63], v[28:31], v[140:143], v[60:63]
    s_sub_u32 s38, s38, 1
    s_cbranch_scc0 L_strip_33
    s_bitcmp1_b32 s30, 0
    s_cbranch_scc1 L_odd_34
    s_waitcnt vmcnt(13) lgkmcnt(2)
    v_cvt_pk_bf16_f32 v96, v32, v33
    v_cvt_pk_bf16_f32 v97, v34, v35
    v_cvt_pk_bf16_f32 v98, v36, v37
    v_cvt_pk_bf16_f32 v99, v38, v39
    v_mfma_f32_16x16x32_bf16 v[64:67], v[16:19], a[0:3], 0
    ds_read_b64_tr_b16 v[24:25], v3 offset:2048
    ds_read_b64_tr_b16 v[26:27], v3 offset:3072
    v_cvt_pk_bf16_f32 v100, v40, v41
    v_cvt_pk_bf16_f32 v101, v42, v43
    v_cvt_pk_bf16_f32 v102, v44, v45
    v_cvt_pk_bf16_f32 v103, v46, v47
    v_mfma_f32_16x16x32_bf16 v[72:75], v[16:19], a[4:7], 0
    buffer_load_dwordx4 v6, s[8:11], s31 offen offset:1024 lds
    v_cvt_pk_bf16_f32 v104, v48, v49
    v_cvt_pk_bf16_f32 v105, v50, v51
    v_cvt_pk_bf16_f32 v106, v52, v53
    v_cvt_pk_bf16_f32 v107, v54, v55
    v_mfma_f32_16x16x32_bf16 v[80:83], v[16:19], a[8:11], 0
    v_cvt_pk_bf16_f32 v108, v56, v57
    v_cvt_pk_bf16_f32 v109, v58, v59
    v_cvt_pk_bf16_f32 v110, v60, v61
    v_cvt_pk_bf16_f32 v111, v62, v63
    v_mfma_f32_16x16x32_bf16 v[88:91], v[16:19], a[12:15], 0
    s_add_u32 m0, s32, 0
    s_mov_b32 s31, s45
    s_waitcnt lgkmcnt(2)
    v_mfma_f32_16x16x32_bf16 v[68:71], v[20:23], a[0:3], 0
    ds_read_b64_tr_b16 v[28:29], v4 offset:2048
    ds_read_b64_tr_b16 v[30:31], v4 offset:3072
    v_mfma_f32_16x16x32_bf16 v[76:79], v[20:23], a[4:7], 0
    buffer_load_dwordx4 v7, s[12:15], s31 offen lds
    v_mfma_f32_16x16x32_bf16 v[84:87], v[20:23], a[8:11], 0
    v_mfma_f32_16x16x32_bf16 v[92:95], v[20:23], a[12:15], 0
    s_waitcnt vmcnt(13) lgkmcnt(2)
    v_mfma_f32_16x16x32_bf16 v[64:67], v[24:27], a[16:19], v[64:67]
    ds_read_b64_tr_b16 v[16:17], v3 offset:4096
    ds_read_b64_tr_b16 v[18:19], v3 offset:5120
    v_add_u32 v9, s50, v1
    v_mfma_f32_16x16x32_bf16 v[72:75], v[24:27], a[20:23], v[72:75]
    buffer_load_dwordx4 v8, s[12:15], s31 offen offset:1024 lds
    v_pk_max_i16 v96, v96, 0
    v_pk_max_i16 v97, v97, 0
    v_mfma_f32_16x16x32_bf16 v[80:83], v[24:27], a[24:27], v[80:83]
    v_pk_max_i16 v98, v98, 0
    v_pk_max_i16 v99, v99, 0
    ds_write_b128 v9, v[96:99] offset:0
    v_mfma_f32_16x16x32_bf16 v[88:91], v[24:27], a[28:31], v[88:91]
    s_add_u32 m0, s32, 2048
    s_add_u32 s31, s31, 36864
    v_pk_max_i16 v100, v100, 0
    s_waitcnt lgkmcnt(3)
    v_mfma_f32_16x16x32_bf16 v[68:71], v[28:31], a[16:19], v[68:71]
    ds_read_b64_tr_b16 v[20:21], v4 offset:4096
    ds_read_b64_tr_b16 v[22:23], v4 offset:5120
    v_pk_max_i16 v101, v101, 0
    v_mfma_f32_16x16x32_bf16 v[76:79], v[28:31], a[20:23], v[76:79]
    buffer_load_dwordx4 v7, s[12:15], s31 offen lds
    v_pk_max_i16 v102, v102, 0
    v_pk_max_i16 v103, v103, 0
    v_mfma_f32_16x16x32_bf16 v[84:87], v[28:31], a[24:27], v[84:87]
    ds_write_b128 v9, v[100:103] offset:1024
    v_mfma_f32_16x16x32_bf16 v[92:95], v[28:31], a[28:31], v[92:95]
    s_waitcnt vmcnt(13) lgkmcnt(4)
    v_mfma_f32_16x16x32_bf16 v[64:67], v[16:19], a[32:35], v[64:67]
    ds_read_b64_tr_b16 v[24:25], v3 offset:6144
    ds_read_b64_tr_b16 v[26:27], v3 offset:7168
    v_pk_max_i16 v104, v104, 0
    v_mfma_f32_16x16x32_bf16 v[72:75], v[16:19], a[36:39], v[72:75]
    buffer_load_dwordx4 v8, s[12:15], s31 offen offset:1024 lds
    v_pk_max_i16 v105, v105, 0
    v_pk_max_i16 v106, v106, 0
    v_mfma_f32_16x16x32_bf16 v[80:83], v[16:19], a[40:43], v[80:83]
    v_pk_max_i16 v107, v107, 0
    ds_write_b128 v9, v[104:107] offset:2048
    v_pk_max_i16 v108, v108, 0
    v_mfma_f32_16x16x32_bf16 v[88:91], v[16:19], a[44:47], v[88:91]
    s_add_u32 m0, s32, 4096
    s_add_u32 s31, s31, 36864
    v_pk_max_i16 v109, v109, 0
    s_waitcnt lgkmcnt(4)
    v_mfma_f32_16x16x32_bf16 v[68:71], v[20:23], a[32:35], v[68:71]
    ds_read_b64_tr_b16 v[28:29], v4 offset:6144
    ds_read_b64_tr_b16 v[30:31], v4 offset:7168
    v_pk_max_i16 v110, v110, 0
    v_mfma_f32_16x16x32_bf16 v[76:79], v[20:23], a[36:39], v[76:79]
    buffer_load_dwordx4 v7, s[12:15], s31 offen lds
    v_pk_max_i16 v111, v111, 0
    ds_write_b128 v9, v[108:111] offset:3072
    v_mfma_f32_16x16x32_bf16 v[84:87], v[20:23], a[40:43], v[84:87]
    v_mfma_f32_16x16x32_bf16 v[92:95], v[20:23], a[44:47], v[92:95]
    s_waitcnt vmcnt(13) lgkmcnt(4)
    v_mfma_f32_16x16x32_bf16 v[64:67], v[24:27], a[48:51], v[64:67]
    ds_read_b64_tr_b16 v[16:17], v3 offset:8192
    ds_read_b64_tr_b16 v[18:19], v3 offset:9216
    v_mfma_f32_16x16x32_bf16 v[72:75], v[24:27], a[52:55], v[72:75]
    buffer_load_dwordx4 v8, s[12:15], s31 offen offset:1024 lds
    v_pk_add_f32 v[180:181], v[180:181], v[182:183]
    v_mfma_f32_16x16x32_bf16 v[80:83], v[24:27], a[56:59], v[80:83]
    v_add_f32 v180, v180, v181
    v_mov_b32 v181, v180
    v_mfma_f32_16x16x32_bf16 v[88:91], v[24:27], a[60:63], v[88:91]
    s_add_u32 m0, s32, 6144
    s_add_u32 s31, s31, 36864
    s_waitcnt lgkmcnt(3)
    v_mfma_f32_16x16x32_bf16 v[68:71], v[28:31], a[48:51], v[68:71]
    ds_read_b64_tr_b16 v[20:21], v4 offset:8192
    ds_read_b64_tr_b16 v[22:23], v4 offset:9216
    v_mfma_f32_16x16x32_bf16 v[76:79], v[28:31], a[52:55], v[76:79]
    buffer_load_dwordx4 v7, s[12:15], s31 offen lds
    s_nop 1
    v_mfma_f32_16x16x32_bf16 v[84:87], v[28:31], a[56:59], v[84:87]
    v_permlane32_swap_b32 v180, v181
    v_add_f32 v180, v180, v181
    v_mfma_f32_16x16x32_bf16 v[92:95], v[28:31], a[60:63], v[92:95]
    v_mov_b32 v181, v180
    s_waitcnt vmcnt(13) lgkmcnt(2)
    v_mfma_f32_16x16x32_bf16 v[64:67], v[16:19], a[64:67], v[64:67]
    ds_read_b64_tr_b16 v[24:25], v3 offset:10240
    ds_read_b64_tr_b16 v[26:27], v3 offset:11264
    v_mfma_f32_16x16x32_bf16 v[72:75], v[16:19], a[68:71], v[72:75]
    buffer_load_dwordx4 v8, s[12:15], s31 offen offset:1024 lds
    s_nop 1
    v_mfma_f32_16x16x32_bf16 v[80:83], v[16:19], a[72:75], v[80:83]
    v_permlane16_swap_b32 v180, v181
    v_add_f32 v180, v180, v181
    v_mfma_f32_16x16x32_bf16 v[88:91], v[16:19], a[76:79], v[88:91]
    s_add_u32 m0, s32, 8192
    s_add_u32 s31, s31, 36864
    s_waitcnt lgkmcnt(2)
    v_mfma_f32_16x16x32_bf16 v[68:71], v[20:23], a[64:67], v[68:71]
    ds_read_b64_tr_b16 v[28:29], v4 offset:10240
    ds_read_b64_tr_b16 v[30:31], v4 offset:11264
    v_mfma_f32_16x16x32_bf16 v[76:79], v[20:23], a[68:71], v[76:79]
    buffer_load_dwordx4 v7, s[12:15], s31 offen lds
    v_mov_b32 v181, 0x3727c5ac
    v_mfma_f32_16x16x32_bf16 v[84:87], v[20:23], a[72:75], v[84:87]
    v_fmac_f32 v181, 0x3ae38e39, v180
    v_rsq_f32 v168, v181
    v_mfma_f32_16x16x32_bf16 v[92:95], v[20:23], a[76:79], v[92:95]
    v_pk_add_f32 v[188:189], v[188:189], v[190:191]
    s_waitcnt vmcnt(13) lgkmcnt(2)
    v_mfma_f32_16x16x32_bf16 v[64:67], v[24:27], a[80:83], v[64:67]
    ds_read_b64_tr_b16 v[16:17], v3 offset:12288
    ds_read_b64_tr_b16 v[18:19], v3 offset:13312
    v_mfma_f32_16x16x32_bf16 v[72:75], v[24:27], a[84:87], v[72:75]
    buffer_load_dwordx4 v8, s[12:15], s31 offen offset:1024 lds
    v_add_f32 v188, v188, v189
    v_mfma_f32_16x16x32_bf16 v[80:83], v[24:27], a[88:91], v[80:83]
    v_mov_b32 v189, v188
    s_nop 1
    v_mfma_f32_16x16x32_bf16 v[88:91], v[24:27], a[92:95], v[88:91]
    s_add_u32 m0, s32, 10240
    s_add_u32 s31, s31, 36864
    s_waitcnt lgkmcnt(2)
    v_mfma_f32_16x16x32_bf16 v[68:71], v[28:31], a[80:83], v[68:71]
    ds_read_b64_tr_b16 v[20:21], v4 offset:12288
    ds_read_b64_tr_b16 v[22:23], v4 offset:13312
    v_mfma_f32_16x16x32_bf16 v[76:79], v[28:31], a[84:87], v[76:79]
    buffer_load_dwordx4 v7, s[12:15], s31 offen lds
    v_permlane32_swap_b32 v188, v189
    v_mfma_f32_16x16x32_bf16 v[84:87], v[28:31], a[88:91], v[84:87]
    v_add_f32 v188, v188, v189
    v_mov_b32 v189, v188
    v_mfma_f32_16x16x32_bf16 v[92:95], v[28:31], a[92:95], v[92:95]
    s_nop 1
    s_waitcnt vmcnt(13) lgkmcnt(2)
    v_mfma_f32_16x16x32_bf16 v[64:67], v[16:19], a[96:99], v[64:67]
    ds_read_b64_tr_b16 v[24:25], v3 offset:14336
    ds_read_b64_tr_b16 v[26:27], v3 offset:15360
    v_mfma_f32_16x16x32_bf16 v[72:75], v[16:19], a[100:103], v[72:75]
    buffer_load_dwordx4 v8, s[12:15], s31 offen offset:1024 lds
    v_permlane16_swap_b32 v188, v189
    v_mfma_f32_16x16x32_bf16 v[80:83], v[16:19], a[104:107], v[80:83]
    v_add_f32 v188, v188, v189
    v_mov_b32 v189, 0x3727c5ac
    v_mfma_f32_16x16x32_bf16 v[88:91], v[16:19], a[108:111], v[88:91]
    s_add_u32 m0, s32, 12288
    s_add_u32 s31, s31, 36864
    s_waitcnt lgkmcnt(2)
    v_mfma_f32_16x16x32_bf16 v[68:71], v[20:23], a[96:99], v[68:71]
    ds_read_b64_tr_b16 v[28:29], v4 offset:14336
    ds_read_b64_tr_b16 v[30:31], v4 offset:15360
    v_mfma_f32_16x16x32_bf16 v[76:79], v[20:23], a[100:103], v[76:79]
    buffer_load_dwordx4 v7, s[12:15], s31 offen lds
    v_fmac_f32 v189, 0x3ae38e39, v188
    v_mfma_f32_16x16x32_bf16 v[84:87], v[20:23], a[104:107], v[84:87]
    v_rsq_f32 v169, v189
    v_pk_add_f32 v[196:197], v[196:197], v[198:199]
    v_mfma_f32_16x16x32_bf16 v[92:95], v[20:23], a[108:111], v[92:95]
    v_add_f32 v196, v196, v197
    s_waitcnt vmcnt(13) lgkmcnt(2)
    v_mfma_f32_16x16x32_bf16 v[64:67], v[24:27], a[112:115], v[64:67]
    ds_read_b64_tr_b16 v[16:17], v3 offset:16384
    ds_read_b64_tr_b16 v[18:19], v3 offset:17408
    v_mfma_f32_16x16x32_bf16 v[72:75], v[24:27], a[116:119], v[72:75]
    buffer_load_dwordx4 v8, s[12:15], s31 offen offset:1024 lds
    v_mov_b32 v197, v196
    v_mfma_f32_16x16x32_bf16 v[80:83], v[24:27], a[120:123], v[80:83]
    s_nop 1
    v_permlane32_swap_b32 v196, v197
    v_mfma_f32_16x16x32_bf16 v[88:91], v[24:27], a[124:127], v[88:91]
    s_add_u32 m0, s32, 14336
    s_add_u32 s31, s31, 36864
    s_waitcnt lgkmcnt(2)
    v_mfma_f32_16x16x32_bf16 v[68:71], v[28:31], a[112:115], v[68:71]
    ds_read_b64_tr_b16 v[20:21], v4 offset:16384
    ds_read_b64_tr_b16 v[22:23], v4 offset:17408
    v_mfma_f32_16x16x32_bf16 v[76:79], v[28:31], a[116:119], v[76:79]
    buffer_load_dwordx4 v7, s[12:15], s31 offen lds
    v_add_f32 v196, v196, v197
    v_mfma_f32_16x16x32_bf16 v[84:87], v[28:31], a[120:123], v[84:87]
    v_mov_b32 v197, v196
    s_nop 1
    v_mfma_f32_16x16x32_bf16 v[92:95], v[28:31], a[124:127], v[92:95]
    v_permlane16_swap_b32 v196, v197
    s_waitcnt vmcnt(13) lgkmcnt(2)
    v_mfma_f32_16x16x32_bf16 v[64:67], v[16:19], a[128:131], v[64:67]
    ds_read_b64_tr_b16 v[24:25], v3 offset:0
    ds_read_b64_tr_b16 v[26:27], v3 offset:1024
    v_mfma_f32_16x16x32_bf16 v[72:75], v[16:19], a[132:135], v[72:75]
    buffer_load_dwordx4 v8, s[12:15], s31 offen offset:1024 lds
    v_add_f32 v196, v196, v197
    v_mfma_f32_16x16x32_bf16 v[80:83], v[16:19], a[136:139], v[80:83]
    v_mov_b32 v197, 0x3727c5ac
    v_fmac_f32 v197, 0x3ae38e39, v196
    v_mfma_f32_16x16x32_bf16 v[88:91], v[16:19], a[140:143], v[88:91]
    s_add_u32 m0, s32, 16384
    s_add_u32 s31, s31, 36864
    s_waitcnt lgkmcnt(2)
    v_mfma_f32_16x16x32_bf16 v[68:71], v[20:23], a[128:131], v[68:71]
    ds_read_b64_tr_b16 v[28:29], v4 offset:0
    ds_read_b64_tr_b16 v[30:31], v4 offset:1024
    v_mfma_f32_16x16x32_bf16 v[76:79], v[20:23], a[132:135], v[76:79]
    buffer_load_dwordx4 v7, s[12:15], s31 offen lds
    v_rsq_f32 v170, v197
    v_mfma_f32_16x16x32_bf16 v[84:87], v[20:23], a[136:139], v[84:87]
    v_mfma_f32_16x16x32_bf16 v[92:95], v[20:23], a[140:143], v[92:95]
    s_branch L_join_35
L_odd_34:
    s_waitcnt vmcnt(13) lgkmcnt(2)
    v_cvt_pk_bf16_f32 v96, v32, v33
    v_cvt_pk_bf16_f32 v97, v34, v35
    v_cvt_pk_bf16_f32 v98, v36, v37
    v_cvt_pk_bf16_f32 v99, v38, v39
    v_mfma_f32_16x16x32_bf16 v[64:67], v[16:19], a[152:155], 0
    ds_read_b64_tr_b16 v[24:25], v3 offset:2048
    ds_read_b64_tr_b16 v[26:27], v3 offset:3072
    v_cvt_pk_bf16_f32 v100, v40, v41
    v_cvt_pk_bf16_f32 v101, v42, v43
    v_cvt_pk_bf16_f32 v102, v44, v45
    v_cvt_pk_bf16_f32 v103, v46, v47
    v_mfma_f32_16x16x32_bf16 v[72:75], v[16:19], a[156:159], 0
    buffer_load_dwordx4 v6, s[8:11], s31 offen offset:1024 lds
    v_cvt_pk_bf16_f32 v104, v48, v49
    v_cvt_pk_bf16_f32 v105, v50, v51
    v_cvt_pk_bf16_f32 v106, v52, v53
    v_cvt_pk_bf16_f32 v107, v54, v55
    v_mfma_f32_16x16x32_bf16 v[80:83], v[16:19], a[144:147], 0
    v_cvt_pk_bf16_f32 v108, v56, v57
    v_cvt_pk_bf16_f32 v109, v58, v59
    v_cvt_pk_bf16_f32 v110, v60, v61
    v_cvt_pk_bf16_f32 v111, v62, v63
    v_mfma_f32_16x16x32_bf16 v[88:91], v[16:19], a[148:151], 0
    s_add_u32 m0, s32, 0
    s_mov_b32 s31, s45
    s_waitcnt lgkmcnt(2)
    v_mfma_f32_16x16x32_bf16 v[68:71], v[20:23], a[152:155], 0
    ds_read_b64_tr_b16 v[28:29], v4 offset:2048
    ds_read_b64_tr_b16 v[30:31], v4 offset:3072
    v_mfma_f32_16x16x32_bf16 v[76:79], v[20:23], a[156:159], 0
    buffer_load_dwordx4 v7, s[12:15], s31 offen lds
    v_mfma_f32_16x16x32_bf16 v[84:87], v[20:23], a[144:147], 0
    v_mfma_f32_16x16x32_bf16 v[92:95], v[20:23], a[148:151], 0
    s_waitcnt vmcnt(13) lgkmcnt(2)
    v_mfma_f32_16x16x32_bf16 v[64:67], v[24:27], a[168:171], v[64:67]
    ds_read_b64_tr_b16 v[16:17], v3 offset:4096
    ds_read_b64_tr_b16 v[18:19], v3 offset:5120
    v_add_u32 v9, s50, v1
    v_mfma_f32_16x16x32_bf16 v[72:75], v[24:27], a[172:175], v[72:75]
    buffer_load_dwordx4 v8, s[12:15], s31 offen offset:1024 lds
    v_pk_max_i16 v96, v96, 0
    v_pk_max_i16 v97, v97, 0
    v_mfma_f32_16x16x32_bf16 v[80:83], v[24:27], a[160:163], v[80:83]
    v_pk_max_i16 v98, v98, 0
    v_pk_max_i16 v99, v99, 0
    ds_write_b128 v9, v[96:99] offset:0
    v_mfma_f32_16x16x32_bf16 v[88:91], v[24:27], a[164:167], v[88:91]
    s_add_u32 m0, s32, 2048
    s_add_u32 s31, s31, 36864
    v_pk_max_i16 v100, v100, 0
    s_waitcnt lgkmcnt(3)
    v_mfma_f32_16x16x32_bf16 v[68:71], v[28:31], a[168:171], v[68:71]
    ds_read_b64_tr_b16 v[20:21], v4 offset:4096
    ds_read_b64_tr_b16 v[22:23], v4 offset:5120
    v_pk_max_i16 v101, v101, 0
    v_mfma_f32_16x16x32_bf16 v[76:79], v[28:31], a[172:175], v[76:79]
    buffer_load_dwordx4 v7, s[12:15], s31 offen lds
    v_pk_max_i16 v102, v102, 0
    v_pk_max_i16 v103, v103, 0
    v_mfma_f32_16x16x32_bf16 v[84:87], v[28:31], a[160:163], v[84:87]
    ds_write_b128 v9, v[100:103] offset:1024
    v_mfma_f32_16x16x32_bf16 v[92:95], v[28:31], a[164:167], v[92:95]
    s_waitcnt vmcnt(13) lgkmcnt(4)
    v_mfma_f32_16x16x32_bf16 v[64:67], v[16:19], a[184:187], v[64:67]
    ds_read_b64_tr_b16 v[24:25], v3 offset:6144
    ds_read_b64_tr_b16 v[26:27], v3 offset:7168
    v_pk_max_i16 v104, v104, 0
    v_mfma_f32_16x16x32_bf16 v[72:75], v[16:19], a[188:191], v[72:75]
    buffer_load_dwordx4 v8, s[12:15], s31 offen offset:1024 lds
    v_pk_max_i16 v105, v105, 0
    v_pk_max_i16 v106, v106, 0
    v_mfma_f32_16x16x32_bf16 v[80:83], v[16:19], a[176:179], v[80:83]
    v_pk_max_i16 v107, v107, 0
    ds_write_b128 v9, v[104:107] offset:2048
    v_pk_max_i16 v108, v108, 0
    v_mfma_f32_16x16x32_bf16 v[88:91], v[16:19], a[180:183], v[88:91]
    s_add_u32 m0, s32, 4096
    s_add_u32 s31, s31, 36864
    v_pk_max_i16 v109, v109, 0
    s_waitcnt lgkmcnt(4)
    v_mfma_f32_16x16x32_bf16 v[68:71], v[20:23], a[184:187], v[68:71]
    ds_read_b64_tr_b16 v[28:29], v4 offset:6144
    ds_read_b64_tr_b16 v[30:31], v4 offset:7168
    v_pk_max_i16 v110, v110, 0
    v_mfma_f32_16x16x32_bf16 v[76:79], v[20:23], a[188:191], v[76:79]
    buffer_load_dwordx4 v7, s[12:15], s31 offen lds
    v_pk_max_i16 v111, v111, 0
    ds_write_b128 v9, v[108:111] offset:3072
    v_mfma_f32_16x16x32_bf16 v[84:87], v[20:23], a[176:179], v[84:87]
    v_mfma_f32_16x16x32_bf16 v[92:95], v[20:23], a[180:183], v[92:95]
    s_waitcnt vmcnt(13) lgkmcnt(4)
    v_mfma_f32_16x16x32_bf16 v[64:67], v[24:27], a[200:203], v[64:67]
    ds_read_b64_tr_b16 v[16:17], v3 offset:8192
    ds_read_b64_tr_b16 v[18:19], v3 offset:9216
    v_mfma_f32_16x16x32_bf16 v[72:75], v[24:27], a[204:207], v[72:75]
    buffer_load_dwordx4 v8, s[12:15], s31 offen offset:1024 lds
    v_pk_add_f32 v[180:181], v[180:181], v[182:183]
    v_mfma_f32_16x16x32_bf16 v[80:83], v[24:27], a[192:195], v[80:83]
    v_add_f32 v180, v180, v181
    v_mov_b32 v181, v180
    v_mfma_f32_16x16x32_bf16 v[88:91], v[24:27], a[196:199], v[88:91]
    s_add_u32 m0, s32, 6144
    s_add_u32 s31, s31, 36864
    s_waitcnt lgkmcnt(3)
    v_mfma_f32_16x16x32_bf16 v[68:71], v[28:31], a[200:203], v[68:71]
    ds_read_b64_tr_b16 v[20:21], v4 offset:8192
    ds_read_b64_tr_b16 v[22:23], v4 offset:9216
    v_mfma_f32_16x16x32_bf16 v[76:79], v[28:31], a[204:207], v[76:79]
    buffer_load_dwordx4 v7, s[12:15], s31 offen lds
    s_nop 1
    v_mfma_f32_16x16x32_bf16 v[84:87], v[28:31], a[192:195], v[84:87]
    v_permlane32_swap_b32 v180, v181
    v_add_f32 v180, v180, v181
    v_mfma_f32_16x16x32_bf16 v[92:95], v[28:31], a[196:199], v[92:95]
    v_mov_b32 v181, v180
    s_waitcnt vmcnt(13) lgkmcnt(2)
    v_mfma_f32_16x16x32_bf16 v[64:67], v[16:19], a[216:219], v[64:67]
    ds_read_b64_tr_b16 v[24:25], v3 offset:10240
    ds_read_b64_tr_b16 v[26:27], v3 offset:11264
    v_mfma_f32_16x16x32_bf16 v[72:75], v[16:19], a[220:223], v[72:75]
    buffer_load_dwordx4 v8, s[12:15], s31 offen offset:1024 lds
    s_nop 1
    v_mfma_f32_16x16x32_bf16 v[80:83], v[16:19], a[208:211], v[80:83]
    v_permlane16_swap_b32 v180, v181
    v_add_f32 v180, v180, v181
    v_mfma_f32_16x16x32_bf16 v[88:91], v[16:19], a[212:215], v[88:91]
    s_add_u32 m0, s32, 8192
    s_add_u32 s31, s31, 36864
    s_waitcnt lgkmcnt(2)
    v_mfma_f32_16x16x32_bf16 v[68:71], v[20:23], a[216:219], v[68:71]
    ds_read_b64_tr_b16 v[28:29], v4 offset:10240
    ds_read_b64_tr_b16 v[30:31], v4 offset:11264
    v_mfma_f32_16x16x32_bf16 v[76:79], v[20:23], a[220:223], v[76:79]
    buffer_load_dwordx4 v7, s[12:15], s31 offen lds
    v_mov_b32 v181, 0x3727c5ac
    v_mfma_f32_16x16x32_bf16 v[84:87], v[20:23], a[208:211], v[84:87]
    v_fmac_f32 v181, 0x3ae38e39, v180
    v_rsq_f32 v168, v181
    v_mfma_f32_16x16x32_bf16 v[92:95], v[20:23], a[212:215], v[92:95]
    v_pk_add_f32 v[188:189], v[188:189], v[190:191]
    s_waitcnt vmcnt(13) lgkmcnt(2)
    v_mfma_f32_16x16x32_bf16 v[64:67], v[24:27], a[232:235], v[64:67]
    ds_read_b64_tr_b16 v[16:17], v3 offset:12288
    ds_read_b64_tr_b16 v[18:19], v3 offset:13312
    v_mfma_f32_16x16x32_bf16 v[72:75], v[24:27], a[236:239], v[72:75]
    buffer_load_dwordx4 v8, s[12:15], s31 offen offset:1024 lds
    v_add_f32 v188, v188, v189
    v_mfma_f32_16x16x32_bf16 v[80:83], v[24:27], a[224:227], v[80:83]
    v_mov_b32 v189, v188
    s_nop 1
    v_mfma_f32_16x16x32_bf16 v[88:91], v[24:27], a[228:231], v[88:91]
    s_add_u32 m0, s32, 10240
    s_add_u32 s31, s31, 36864
    s_waitcnt lgkmcnt(2)
    v_mfma_f32_16x16x32_bf16 v[68:71], v[28:31], a[232:235], v[68:71]
    ds_read_b64_tr_b16 v[20:21], v4 offset:12288
    ds_read_b64_tr_b16 v[22:23], v4 offset:13312
    v_mfma_f32_16x16x32_bf16 v[76:79], v[28:31], a[236:239], v[76:79]
    buffer_load_dwordx4 v7, s[12:15], s31 offen lds
    v_permlane32_swap_b32 v188, v189
    v_mfma_f32_16x16x32_bf16 v[84:87], v[28:31], a[224:227], v[84:87]
    v_add_f32 v188, v188, v189
    v_mov_b32 v189, v188
    v_mfma_f32_16x16x32_bf16 v[92:95], v[28:31], a[228:231], v[92:95]
    s_nop 1
    s_waitcnt vmcnt(13) lgkmcnt(2)
    v_mfma_f32_16x16x32_bf16 v[64:67], v[16:19], a[248:251], v[64:67]
    ds_read_b64_tr_b16 v[24:25], v3 offset:14336
    ds_read_b64_tr_b16 v[26:27], v3 offset:15360
    v_mfma_f32_16x16x32_bf16 v[72:75], v[16:19], a[252:255], v[72:75]
    buffer_load_dwordx4 v8, s[12:15], s31 offen offset:1024 lds
    v_permlane16_swap_b32 v188, v189
    v_mfma_f32_16x16x32_bf16 v[80:83], v[16:19], a[240:243], v[80:83]
    v_add_f32 v188, v188, v189
    v_mov_b32 v189, 0x3727c5ac
    v_mfma_f32_16x16x32_bf16 v[88:91], v[16:19], a[244:247], v[88:91]
    s_add_u32 m0, s32, 12288
    s_add_u32 s31, s31, 36864
    s_waitcnt lgkmcnt(2)
    v_mfma_f32_16x16x32_bf16 v[68:71], v[20:23], a[248:251], v[68:71]
    ds_read_b64_tr_b16 v[28:29], v4 offset:14336
    ds_read_b64_tr_b16 v[30:31], v4 offset:15360
    v_mfma_f32_16x16x32_bf16 v[76:79], v[20:23], a[252:255], v[76:79]
    buffer_load_dwordx4 v7, s[12:15], s31 offen lds
    v_fmac_f32 v189, 0x3ae38e39, v188
    v_mfma_f32_16x16x32_bf16 v[84:87], v[20:23], a[240:243], v[84:87]
    v_rsq_f32 v169, v189
    v_pk_add_f32 v[196:197], v[196:197], v[198:199]
    v_mfma_f32_16x16x32_bf16 v[92:95], v[20:23], a[244:247], v[92:95]
    v_add_f32 v196, v196, v197
    s_waitcnt vmcnt(13) lgkmcnt(2)
    v_mfma_f32_16x16x32_bf16 v[64:67], v[24:27], v[120:123], v[64:67]
    ds_read_b64_tr_b16 v[16:17], v3 offset:16384
    ds_read_b64_tr_b16 v[18:19], v3 offset:17408
    v_mfma_f32_16x16x32_bf16 v[72:75], v[24:27], v[124:127], v[72:75]
    buffer_load_dwordx4 v8, s[12:15], s31 offen offset:1024 lds
    v_mov_b32 v197, v196
    v_mfma_f32_16x16x32_bf16 v[80:83], v[24:27], v[112:115], v[80:83]
    s_nop 1
    v_permlane32_swap_b32 v196, v197
    v_mfma_f32_16x16x32_bf16 v[88:91], v[24:27], v[116:119], v[88:91]
    s_add_u32 m0, s32, 14336
    s_add_u32 s31, s31, 36864
    s_waitcnt lgkmcnt(2)
    v_mfma_f32_16x16x32_bf16 v[68:71], v[28:31], v[120:123], v[68:71]
    ds_read_b64_tr_b16 v[20:21], v4 offset:16384
    ds_read_b64_tr_b16 v[22:23], v4 offset:17408
    v_mfma_f32_16x16x32_bf16 v[76:79], v[28:31], v[124:127], v[76:79]
    buffer_load_dwordx4 v7, s[12:15], s31 offen lds
    v_add_f32 v196, v196, v197
    v_mfma_f32_16x16x32_bf16 v[84:87], v[28:31], v[112:115], v[84:87]
    v_mov_b32 v197, v196
    s_nop 1
    v_mfma_f32_16x16x32_bf16 v[92:95], v[28:31], v[116:119], v[92:95]
    v_permlane16_swap_b32 v196, v197
    s_waitcnt vmcnt(13) lgkmcnt(2)
    v_mfma_f32_16x16x32_bf16 v[64:67], v[16:19], v[136:139], v[64:67]
    ds_read_b64_tr_b16 v[24:25], v3 offset:0
    ds_read_b64_tr_b16 v[26:27], v3 offset:1024
    v_mfma_f32_16x16x32_bf16 v[72:75], v[16:19], v[140:143], v[72:75]
    buffer_load_dwordx4 v8, s[12:15], s31 offen offset:1024 lds
    v_add_f32 v196, v196, v197
    v_mfma_f32_16x16x32_bf16 v[80:83], v[16:19], v[128:131], v[80:83]
    v_mov_b32 v197, 0x3727c5ac
    v_fmac_f32 v197, 0x3ae38e39, v196
    v_mfma_f32_16x16x32_bf16 v[88:91], v[16:19], v[132:135], v[88:91]
    s_add_u32 m0, s32, 16384
    s_add_u32 s31, s31, 36864
    s_waitcnt lgkmcnt(2)
    v_mfma_f32_16x16x32_bf16 v[68:71], v[20:23], v[136:139], v[68:71]
    ds_read_b64_tr_b16 v[28:29], v4 offset:0
    ds_read_b64_tr_b16 v[30:31], v4 offset:1024
    v_mfma_f32_16x16x32_bf16 v[76:79], v[20:23], v[140:143], v[76:79]
    buffer_load_dwordx4 v7, s[12:15], s31 offen lds
    v_rsq_f32 v170, v197
    v_mfma_f32_16x16x32_bf16 v[84:87], v[20:23], v[128:131], v[84:87]
    v_mfma_f32_16x16x32_bf16 v[92:95], v[20:23], v[132:135], v[92:95]
L_join_35:
    s_lshl_b32 s33, s30, 11
    s_add_u32 s33, s33, 0x10000
    v_add_u32 v9, s33, v1
    s_nop 4
    ds_write_b128 v10, v[80:83] offset:0
    ds_write_b128 v10, v[84:87] offset:1024
    ds_write_b128 v10, v[88:91] offset:2048
    ds_write_b128 v10, v[92:95] offset:3072
    s_waitcnt lgkmcnt(0)
    s_barrier
    ds_read_b128 a[0:3], v1 offset:0
    ds_read_b128 a[4:7], v1 offset:1024
    ds_read_b128 a[8:11], v1 offset:2048
    ds_read_b128 a[12:15], v1 offset:3072
    ds_read_b128 a[16:19], v1 offset:4096
    ds_read_b128 a[20:23], v1 offset:5120
    ds_read_b128 a[24:27], v1 offset:6144
    ds_read_b128 a[28:31], v1 offset:7168
    s_waitcnt vmcnt(13) lgkmcnt(4)
    v_mfma_f32_16x16x32_bf16 v[32:35], v[24:27], a[0:3], 0
    ds_read_b64_tr_b16 v[16:17], v3 offset:2048
    ds_read_b64_tr_b16 v[18:19], v3 offset:3072
    v_mfma_f32_16x16x32_bf16 v[40:43], v[24:27], a[4:7], 0
    buffer_load_dwordx4 v8, s[12:15], s31 offen offset:1024 lds
    ds_read_b128 a[32:35], v1 offset:8192
    v_mfma_f32_16x16x32_bf16 v[48:51], v[24:27], a[8:11], 0
    ds_read_b128 a[36:39], v1 offset:9216
    ds_read_b128 a[40:43], v1 offset:10240
    v_mfma_f32_16x16x32_bf16 v[56:59], v[24:27], a[12:15], 0
    s_add_u32 m0, s32, 0
    s_add_u32 s31, s31, 36864
    v_mfma_f32_16x16x32_bf16 v[36:39], v[28:31], a[0:3], 0
    ds_read_b64_tr_b16 v[20:21], v4 offset:2048
    ds_read_b64_tr_b16 v[22:23], v4 offset:3072
    v_mfma_f32_16x16x32_bf16 v[44:47], v[28:31], a[4:7], 0
    buffer_load_dwordx4 v7, s[12:15], s31 offen lds
    ds_read_b128 a[44:47], v1 offset:11264
    v_mfma_f32_16x16x32_bf16 v[52:55], v[28:31], a[8:11], 0
    ds_read_b128 v[96:99], v11 offset:0
    ds_read_b128 v[100:103], v11 offset:1024
    v_mfma_f32_16x16x32_bf16 v[60:63], v[28:31], a[12:15], 0
    ds_read_b128 v[104:107], v11 offset:2048
    ds_read_b128 v[108:111], v11 offset:3072
    s_waitcnt vmcnt(13) lgkmcnt(10)
    v_mfma_f32_16x16x32_bf16 v[32:35], v[16:19], a[16:19], v[32:35]
    ds_read_b64_tr_b16 v[24:25], v3 offset:4096
    ds_read_b64_tr_b16 v[26:27], v3 offset:5120
    v_mfma_f32_16x16x32_bf16 v[40:43], v[16:19], a[20:23], v[40:43]
    buffer_load_dwordx4 v8, s[12:15], s31 offen offset:1024 lds
    ds_read_b128 a[48:51], v1 offset:12288
    v_mfma_f32_16x16x32_bf16 v[48:51], v[16:19], a[24:27], v[48:51]
    ds_read_b128 a[52:55], v1 offset:13312
    ds_read_b128 a[56:59], v1 offset:14336
    v_mfma_f32_16x16x32_bf16 v[56:59], v[16:19], a[28:31], v[56:59]
    s_add_u32 m0, s32, 2048
    s_add_u32 s31, s31, 36864
    s_waitcnt lgkmcnt(10)
    v_mfma_f32_16x16x32_bf16 v[36:39], v[20:23], a[16:19], v[36:39]
    ds_read_b64_tr_b16 v[28:29], v4 offset:4096
    ds_read_b64_tr_b16 v[30:31], v4 offset:5120
    v_mfma_f32_16x16x32_bf16 v[44:47], v[20:23], a[20:23], v[44:47]
    buffer_load_dwordx4 v7, s[12:15], s31 offen lds
    ds_read_b128 a[60:63], v1 offset:15360
    v_mfma_f32_16x16x32_bf16 v[52:55], v[20:23], a[24:27], v[52:55]
    v_mfma_f32_16x16x32_bf16 v[60:63], v[20:23], a[28:31], v[60:63]
    s_waitcnt vmcnt(13) lgkmcnt(6)
    v_mfma_f32_16x16x32_bf16 v[32:35], v[24:27], a[32:35], v[32:35]
    ds_read_b64_tr_b16 v[16:17], v3 offset:6144
    ds_read_b64_tr_b16 v[18:19], v3 offset:7168
    ds_read_b128 a[64:67], v1 offset:16384
    v_mfma_f32_16x16x32_bf16 v[40:43], v[24:27], a[36:39], v[40:43]
    buffer_load_dwordx4 v8, s[12:15], s31 offen offset:1024 lds
    ds_read_b128 a[68:71], v1 offset:17408
    ds_read_b128 a[72:75], v1 offset:18432
    v_mfma_f32_16x16x32_bf16 v[48:51], v[24:27], a[40:43], v[48:51]
    ds_read_b128 a[76:79], v1 offset:19456
    v_add_f32 v64, v64, v96
    v_mfma_f32_16x16x32_bf16 v[56:59], v[24:27], a[44:47], v[56:59]
    s_add_u32 m0, s32, 4096
    s_add_u32 s31, s31, 36864
    v_add_f32 v65, v65, v97
    s_waitcnt lgkmcnt(7)
    v_mfma_f32_16x16x32_bf16 v[36:39], v[28:31], a[32:35], v[36:39]
    ds_read_b64_tr_b16 v[20:21], v4 offset:6144
    ds_read_b64_tr_b16 v[22:23], v4 offset:7168
    v_add_f32 v66, v66, v98
    v_mfma_f32_16x16x32_bf16 v[44:47], v[28:31], a[36:39], v[44:47]
    buffer_load_dwordx4 v7, s[12:15], s31 offen lds
    v_add_f32 v67, v67, v99
    v_add_f32 v68, v68, v100
    v_mfma_f32_16x16x32_bf16 v[52:55], v[28:31], a[40:43], v[52:55]
    v_add_f32 v69, v69, v101
    v_add_f32 v70, v70, v102
    v_add_f32 v71, v71, v103
    v_mfma_f32_16x16x32_bf16 v[60:63], v[28:31], a[44:47], v[60:63]
    s_waitcnt vmcnt(13) lgkmcnt(6)
    v_mfma_f32_16x16x32_bf16 v[32:35], v[16:19], a[48:51], v[32:35]
    ds_read_b64_tr_b16 v[24:25], v3 offset:8192
    ds_read_b64_tr_b16 v[26:27], v3 offset:9216
    ds_read_b128 a[80:83], v1 offset:20480
    v_mfma_f32_16x16x32_bf16 v[40:43], v[16:19], a[52:55], v[40:43]
    buffer_load_dwordx4 v8, s[12:15], s31 offen offset:1024 lds
    ds_read_b128 a[84:87], v1 offset:21504
    ds_read_b128 a[88:91], v1 offset:22528
    v_mfma_f32_16x16x32_bf16 v[48:51], v[16:19], a[56:59], v[48:51]
    ds_read_b128 a[92:95], v1 offset:23552
    v_add_f32 v72, v72, v104
    v_add_f32 v73, v73, v105
    v_mfma_f32_16x16x32_bf16 v[56:59], v[16:19], a[60:63], v[56:59]
    s_add_u32 m0, s32, 6144
    s_add_u32 s31, s31, 36864
    v_add_f32 v74, v74, v106
    s_waitcnt lgkmcnt(6)
    v_mfma_f32_16x16x32_bf16 v[36:39], v[20:23], a[48:51], v[36:39]
    ds_read_b64_tr_b16 v[28:29], v4 offset:8192
    ds_read_b64_tr_b16 v[30:31], v4 offset:9216
    v_add_f32 v75, v75, v107
    v_mfma_f32_16x16x32_bf16 v[44:47], v[20:23], a[52:55], v[44:47]
    buffer_load_dwordx4 v7, s[12:15], s31 offen lds
    v_add_f32 v76, v76, v108
    v_add_f32 v77, v77, v109
    v_mfma_f32_16x16x32_bf16 v[52:55], v[20:23], a[56:59], v[52:55]
    v_add_f32 v78, v78, v110
    v_add_f32 v79, v79, v111
    v_mfma_f32_16x16x32_bf16 v[60:63], v[20:23], a[60:63], v[60:63]
    s_waitcnt vmcnt(13) lgkmcnt(6)
    v_mfma_f32_16x16x32_bf16 v[32:35], v[24:27], a[64:67], v[32:35]
    ds_read_b64_tr_b16 v[16:17], v3 offset:10240
    ds_read_b64_tr_b16 v[18:19], v3 offset:11264
    ds_read_b128 a[96:99], v1 offset:24576
    v_mfma_f32_16x16x32_bf16 v[40:43], v[24:27], a[68:71], v[40:43]
    buffer_load_dwordx4 v8, s[12:15], s31 offen offset:1024 lds
    ds_read_b128 a[100:103], v1 offset:25600
    ds_read_b128 a[104:107], v1 offset:26624
    v_mfma_f32_16x16x32_bf16 v[48:51], v[24:27], a[72:75], v[48:51]
    ds_read_b128 a[108:111], v1 offset:27648
    v_cvt_pk_bf16_f32 v96, v64, v65
    v_cvt_pk_bf16_f32 v97, v66, v67
    v_mfma_f32_16x16x32_bf16 v[56:59], v[24:27], a[76:79], v[56:59]
    s_add_u32 m0, s32, 8192
    s_add_u32 s31, s31, 36864
    v_cvt_pk_bf16_f32 v98, v68, v69
    s_waitcnt lgkmcnt(6)
    v_mfma_f32_16x16x32_bf16 v[36:39], v[28:31], a[64:67], v[36:39]
    ds_read_b64_tr_b16 v[20:21], v4 offset:10240
    ds_read_b64_tr_b16 v[22:23], v4 offset:11264
    v_cvt_pk_bf16_f32 v99, v70, v71
    v_mfma_f32_16x16x32_bf16 v[44:47], v[28:31], a[68:71], v[44:47]
    buffer_load_dwordx4 v7, s[12:15], s31 offen lds
    v_pk_max_i16 v96, v96, 0
    v_pk_max_i16 v97, v97, 0
    v_mfma_f32_16x16x32_bf16 v[52:55], v[28:31], a[72:75], v[52:55]
    v_pk_max_i16 v98, v98, 0
    v_pk_max_i16 v99, v99, 0
    ds_write_b128 v9, v[96:99] offset:0
    v_mfma_f32_16x16x32_bf16 v[60:63], v[28:31], a[76:79], v[60:63]
    s_waitcnt vmcnt(13) lgkmcnt(7)
    v_mfma_f32_16x16x32_bf16 v[32:35], v[16:19], a[80:83], v[32:35]
    ds_read_b64_tr_b16 v[24:25], v3 offset:12288
    ds_read_b64_tr_b16 v[26:27], v3 offset:13312
    ds_read_b128 a[112:115], v1 offset:28672
    v_mfma_f32_16x16x32_bf16 v[40:43], v[16:19], a[84:87], v[40:43]
    buffer_load_dwordx4 v8, s[12:15], s31 offen offset:1024 lds
    ds_read_b128 a[116:119], v1 offset:29696
    ds_read_b128 a[120:123], v1 offset:30720
    v_mfma_f32_16x16x32_bf16 v[48:51], v[16:19], a[88:91], v[48:51]
    ds_read_b128 a[124:127], v1 offset:31744
    v_cvt_pk_bf16_f32 v100, v72, v73
    v_cvt_pk_bf16_f32 v101, v74, v75
    v_mfma_f32_16x16x32_bf16 v[56:59], v[16:19], a[92:95], v[56:59]
    s_add_u32 m0, s32, 10240
    s_add_u32 s31, s31, 36864
    v_cvt_pk_bf16_f32 v102, v76, v77
    s_waitcnt lgkmcnt(7)
    v_mfma_f32_16x16x32_bf16 v[36:39], v[20:23], a[80:83], v[36:39]
    ds_read_b64_tr_b16 v[28:29], v4 offset:12288
    ds_read_b64_tr_b16 v[30:31], v4 offset:13312
    v_cvt_pk_bf16_f32 v103, v78, v79
    v_mfma_f32_16x16x32_bf16 v[44:47], v[20:23], a[84:87], v[44:47]
    buffer_load_dwordx4 v7, s[12:15], s31 offen lds
    v_pk_max_i16 v100, v100, 0
    v_pk_max_i16 v101, v101, 0
    v_mfma_f32_16x16x32_bf16 v[52:55], v[20:23], a[88:91], v[52:55]
    v_pk_max_i16 v102, v102, 0
    v_pk_max_i16 v103, v103, 0
    ds_write_b128 v9, v[100:103] offset:1024
    v_mfma_f32_16x16x32_bf16 v[60:63], v[20:23], a[92:95], v[60:63]
    s_waitcnt vmcnt(13) lgkmcnt(7)
    v_mfma_f32_16x16x32_bf16 v[32:35], v[24:27], a[96:99], v[32:35]
    ds_read_b64_tr_b16 v[16:17], v3 offset:14336
    ds_read_b64_tr_b16 v[18:19], v3 offset:15360
    v_mfma_f32_16x16x32_bf16 v[40:43], v[24:27], a[100:103], v[40:43]
    buffer_load_dwordx4 v8, s[12:15], s31 offen offset:1024 lds
    ds_read_b128 a[128:131], v1 offset:32768
    v_mfma_f32_16x16x32_bf16 v[48:51], v[24:27], a[104:107], v[48:51]
    ds_read_b128 a[132:135], v1 offset:33792
    ds_read_b128 a[136:139], v1 offset:34816
    v_mfma_f32_16x16x32_bf16 v[56:59], v[24:27], a[108:111], v[56:59]
    s_add_u32 m0, s32, 12288
    s_add_u32 s31, s31, 36864
    s_waitcnt lgkmcnt(6)
    v_mfma_f32_16x16x32_bf16 v[36:39], v[28:31], a[96:99], v[36:39]
    ds_read_b64_tr_b16 v[20:21], v4 offset:14336
    ds_read_b64_tr_b16 v[22:23], v4 offset:15360
    v_mfma_f32_16x16x32_bf16 v[44:47], v[28:31], a[100:103], v[44:47]
    buffer_load_dwordx4 v7, s[12:15], s31 offen lds
    ds_read_b128 a[140:143], v1 offset:35840
    v_mfma_f32_16x16x32_bf16 v[52:55], v[28:31], a[104:107], v[52:55]
    v_mfma_f32_16x16x32_bf16 v[60:63], v[28:31], a[108:111], v[60:63]
    s_waitcnt vmcnt(13) lgkmcnt(6)
    v_mfma_f32_16x16x32_bf16 v[32:35], v[16:19], a[112:115], v[32:35]
    ds_read_b64_tr_b16 v[24:25], v3 offset:16384
    ds_read_b64_tr_b16 v[26:27], v3 offset:17408
    v_mfma_f32_16x16x32_bf16 v[40:43], v[16:19], a[116:119], v[40:43]
    buffer_load_dwordx4 v8, s[12:15], s31 offen offset:1024 lds
    ds_read_b128 a[144:147], v1 offset:36864
    v_mfma_f32_16x16x32_bf16 v[48:51], v[16:19], a[120:123], v[48:51]
    ds_read_b128 a[148:151], v1 offset:37888
    ds_read_b128 a[152:155], v1 offset:38912
    v_mfma_f32_16x16x32_bf16 v[56:59], v[16:19], a[124:127], v[56:59]
    s_add_u32 m0, s32, 14336
    s_add_u32 s31, s31, 36864
    s_waitcnt lgkmcnt(6)
    v_mfma_f32_16x16x32_bf16 v[36:39], v[20:23], a[112:115], v[36:39]
    ds_read_b64_tr_b16 v[28:29], v4 offset:16384
    ds_read_b64_tr_b16 v[30:31], v4 offset:17408
    v_mfma_f32_16x16x32_bf16 v[44:47], v[20:23], a[116:119], v[44:47]
    buffer_load_dwordx4 v7, s[12:15], s31 offen lds
    ds_read_b128 a[156:159], v1 offset:39936
    v_mfma_f32_16x16x32_bf16 v[52:55], v[20:23], a[120:123], v[52:55]
    v_mfma_f32_16x16x32_bf16 v[60:63], v[20:23], a[124:127], v[60:63]
    s_waitcnt vmcnt(13) lgkmcnt(6)
    v_mfma_f32_16x16x32_bf16 v[32:35], v[24:27], a[128:131], v[32:35]
    ds_read_b64_tr_b16 v[16:17], v3 offset:0
    ds_read_b64_tr_b16 v[18:19], v3 offset:1024
    v_mfma_f32_16x16x32_bf16 v[40:43], v[24:27], a[132:135], v[40:43]
    buffer_load_dwordx4 v8, s[12:15], s31 offen offset:1024 lds
    ds_read_b128 a[160:163], v1 offset:40960
    v_mfma_f32_16x16x32_bf16 v[48:51], v[24:27], a[136:139], v[48:51]
    ds_read_b128 a[164:167], v1 offset:41984
    ds_read_b128 a[168:171], v1 offset:43008
    v_mfma_f32_16x16x32_bf16 v[56:59], v[24:27], a[140:143], v[56:59]
    s_add_u32 m0, s32, 16384
    s_add_u32 s31, s31, 36864
    s_waitcnt lgkmcnt(6)
    v_mfma_f32_16x16x32_bf16 v[36:39], v[28:31], a[128:131], v[36:39]
    ds_read_b64_tr_b16 v[20:21], v4 offset:0
    ds_read_b64_tr_b16 v[22:23], v4 offset:1024
    v_mfma_f32_16x16x32_bf16 v[44:47], v[28:31], a[132:135], v[44:47]
    buffer_load_dwordx4 v7, s[12:15], s31 offen lds
    ds_read_b128 a[172:175], v1 offset:44032
    v_mfma_f32_16x16x32_bf16 v[52:55], v[28:31], a[136:139], v[52:55]
    s_barrier
    v_mfma_f32_16x16x32_bf16 v[60:63], v[28:31], a[140:143], v[60:63]
    s_waitcnt vmcnt(13) lgkmcnt(6)
    v_mfma_f32_16x16x32_bf16 v[32:35], v[16:19], a[144:147], v[32:35]
    ds_read_b64_tr_b16 v[24:25], v3 offset:2048
    ds_read_b64_tr_b16 v[26:27], v3 offset:3072
    v_mfma_f32_16x16x32_bf16 v[40:43], v[16:19], a[148:151], v[40:43]
    buffer_load_dwordx4 v8, s[12:15], s31 offen offset:1024 lds
    ds_read_b128 a[176:179], v1 offset:45056
    v_mfma_f32_16x16x32_bf16 v[48:51], v[16:19], a[152:155], v[48:51]
    ds_read_b128 a[180:183], v1 offset:46080
    ds_read_b128 a[184:187], v1 offset:47104
    v_mfma_f32_16x16x32_bf16 v[56:59], v[16:19], a[156:159], v[56:59]
    s_add_u32 m0, s32, 0
    s_mov_b32 s31, s46
    s_waitcnt lgkmcnt(6)
    v_mfma_f32_16x16x32_bf16 v[36:39], v[20:23], a[144:147], v[36:39]
    ds_read_b64_tr_b16 v[28:29], v4 offset:2048
    ds_read_b64_tr_b16 v[30:31], v4 offset:3072
    v_mfma_f32_16x16x32_bf16 v[44:47], v[20:23], a[148:151], v[44:47]
    buffer_load_dwordx4 v7, s[12:15], s31 offen lds
    ds_read_b128 a[188:191], v1 offset:48128
    v_mfma_f32_16x16x32_bf16 v[52:55], v[20:23], a[152:155], v[52:55]
    v_mfma_f32_16x16x32_bf16 v[60:63], v[20:23], a[156:159], v[60:63]
    s_waitcnt vmcnt(13) lgkmcnt(6)
    v_mfma_f32_16x16x32_bf16 v[32:35], v[24:27], a[160:163], v[32:35]
    ds_read_b64_tr_b16 v[16:17], v3 offset:4096
    ds_read_b64_tr_b16 v[18:19], v3 offset:5120
    v_mfma_f32_16x16x32_bf16 v[40:43], v[24:27], a[164:167], v[40:43]
    buffer_load_dwordx4 v8, s[12:15], s31 offen offset:1024 lds
    ds_read_b128 a[192:195], v1 offset:49152
    v_mfma_f32_16x16x32_bf16 v[48:51], v[24:27], a[168:171], v[48:51]
    ds_read_b128 a[196:199], v1 offset:50176
    ds_read_b128 a[200:203], v1 offset:51200
    v_mfma_f32_16x16x32_bf16 v[56:59], v[24:27], a[172:175], v[56:59]
    s_add_u32 m0, s32, 2048
    s_add_u32 s31, s31, 36864
    s_waitcnt lgkmcnt(6)
    v_mfma_f32_16x16x32_bf16 v[36:39], v[28:31], a[160:163], v[36:39]
    ds_read_b64_tr_b16 v[20:21], v4 offset:4096
    ds_read_b64_tr_b16 v[22:23], v4 offset:5120
    v_mfma_f32_16x16x32_bf16 v[44:47], v[28:31], a[164:167], v[44:47]
    buffer_load_dwordx4 v7, s[12:15], s31 offen lds
    ds_read_b128 a[204:207], v1 offset:52224
    v_mfma_f32_16x16x32_bf16 v[52:55], v[28:31], a[168:171], v[52:55]
    v_mfma_f32_16x16x32_bf16 v[60:63], v[28:31], a[172:175], v[60:63]
    s_waitcnt vmcnt(13) lgkmcnt(6)
    v_mfma_f32_16x16x32_bf16 v[32:35], v[16:19], a[176:179], v[32:35]
    ds_read_b64_tr_b16 v[24:25], v3 offset:6144
    ds_read_b64_tr_b16 v[26:27], v3 offset:7168
    v_mfma_f32_16x16x32_bf16 v[40:43], v[16:19], a[180:183], v[40:43]
    buffer_load_dwordx4 v8, s[12:15], s31 offen offset:1024 lds
    ds_read_b128 a[208:211], v1 offset:53248
    v_mfma_f32_16x16x32_bf16 v[48:51], v[16:19], a[184:187], v[48:51]
    ds_read_b128 a[212:215], v1 offset:54272
    ds_read_b128 a[216:219], v1 offset:55296
    v_mfma_f32_16x16x32_bf16 v[56:59], v[16:19], a[188:191], v[56:59]
    s_add_u32 m0, s32, 4096
    s_add_u32 s31, s31, 36864
    s_waitcnt lgkmcnt(6)
    v_mfma_f32_16x16x32_bf16 v[36:39], v[20:23], a[176:179], v[36:39]
    ds_read_b64_tr_b16 v[28:29], v4 offset:6144
    ds_read_b64_tr_b16 v[30:31], v4 offset:7168
    v_mfma_f32_16x16x32_bf16 v[44:47], v[20:23], a[180:183], v[44:47]
    buffer_load_dwordx4 v7, s[12:15], s31 offen lds
    ds_read_b128 a[220:223], v1 offset:56320
    v_mfma_f32_16x16x32_bf16 v[52:55], v[20:23], a[184:187], v[52:55]
    v_mfma_f32_16x16x32_bf16 v[60:63], v[20:23], a[188:191], v[60:63]
    s_waitcnt vmcnt(13) lgkmcnt(6)
    v_mfma_f32_16x16x32_bf16 v[32:35], v[24:27], a[192:195], v[32:35]
    ds_read_b64_tr_b16 v[16:17], v3 offset:8192
    ds_read_b64_tr_b16 v[18:19], v3 offset:9216
    v_mfma_f32_16x16x32_bf16 v[40:43], v[24:27], a[196:199], v[40:43]
    buffer_load_dwordx4 v8, s[12:15], s31 offen offset:1024 lds
    ds_read_b128 a[224:227], v1 offset:57344
    v_mfma_f32_16x16x32_bf16 v[48:51], v[24:27], a[200:203], v[48:51]
    ds_read_b128 a[228:231], v1 offset:58368
    ds_read_b128 a[232:235], v1 offset:59392
    v_mfma_f32_16x16x32_bf16 v[56:59], v[24:27], a[204:207], v[56:59]
    s_add_u32 m0, s32, 6144
    s_add_u32 s31, s31, 36864
    s_waitcnt lgkmcnt(6)
    v_mfma_f32_16x16x32_bf16 v[36:39], v[28:31], a[192:195], v[36:39]
    ds_read_b64_tr_b16 v[20:21], v4 offset:8192
    ds_read_b64_tr_b16 v[22:23], v4 offset:9216
    v_mfma_f32_16x16x32_bf16 v[44:47], v[28:31], a[196:199], v[44:47]
    buffer_load_dwordx4 v7, s[12:15], s31 offen lds
    ds_read_b128 a[236:239], v1 offset:60416
    v_mfma_f32_16x16x32_bf16 v[52:55], v[28:31], a[200:203], v[52:55]
    v_mfma_f32_16x16x32_bf16 v[60:63], v[28:31], a[204:207], v[60:63]
    s_waitcnt vmcnt(13) lgkmcnt(6)
    v_mfma_f32_16x16x32_bf16 v[32:35], v[16:19], a[208:211], v[32:35]
    ds_read_b64_tr_b16 v[24:25], v3 offset:10240
    ds_read_b64_tr_b16 v[26:27], v3 offset:11264
    v_mfma_f32_16x16x32_bf16 v[40:43], v[16:19], a[212:215], v[40:43]
    buffer_load_dwordx4 v8, s[12:15], s31 offen offset:1024 lds
    ds_read_b128 a[240:243], v1 offset:61440
    v_mfma_f32_16x16x32_bf16 v[48:51], v[16:19], a[216:219], v[48:51]
    ds_read_b128 a[244:247], v1 offset:62464
    ds_read_b128 a[248:251], v1 offset:63488
    v_mfma_f32_16x16x32_bf16 v[56:59], v[16:19], a[220:223], v[56:59]
    s_add_u32 m0, s32, 8192
    s_add_u32 s31, s31, 36864
    s_waitcnt lgkmcnt(6)
    v_mfma_f32_16x16x32_bf16 v[36:39], v[20:23], a[208:211], v[36:39]
    ds_read_b64_tr_b16 v[28:29], v4 offset:10240
    ds_read_b64_tr_b16 v[30:31], v4 offset:11264
    v_mfma_f32_16x16x32_bf16 v[44:47], v[20:23], a[212:215], v[44:47]
    buffer_load_dwordx4 v7, s[12:15], s31 offen lds
    ds_read_b128 a[252:255], v1 offset:64512
    v_mfma_f32_16x16x32_bf16 v[52:55], v[20:23], a[216:219], v[52:55]
    v_mfma_f32_16x16x32_bf16 v[60:63], v[20:23], a[220:223], v[60:63]
    s_waitcnt vmcnt(13) lgkmcnt(6)
    v_mfma_f32_16x16x32_bf16 v[32:35], v[24:27], a[224:227], v[32:35]
    ds_read_b64_tr_b16 v[16:17], v3 offset:12288
    ds_read_b64_tr_b16 v[18:19], v3 offset:13312
    v_mfma_f32_16x16x32_bf16 v[40:43], v[24:27], a[228:231], v[40:43]
    buffer_load_dwordx4 v8, s[12:15], s31 offen offset:1024 lds
    ds_read_b128 v[112:115], v2 offset:0
    v_mfma_f32_16x16x32_bf16 v[48:51], v[24:27], a[232:235], v[48:51]
    ds_read_b128 v[116:119], v2 offset:1024
    ds_read_b128 v[120:123], v2 offset:2048
    v_mfma_f32_16x16x32_bf16 v[56:59], v[24:27], a[236:239], v[56:59]
    s_add_u32 m0, s32, 10240
    s_add_u32 s31, s31, 36864
    s_waitcnt lgkmcnt(6)
    v_mfma_f32_16x16x32_bf16 v[36:39], v[28:31], a[224:227], v[36:39]
    ds_read_b64_tr_b16 v[20:21], v4 offset:12288
    ds_read_b64_tr_b16 v[22:23], v4 offset:13312
    v_mfma_f32_16x16x32_bf16 v[44:47], v[28:31], a[228:231], v[44:47]
    buffer_load_dwordx4 v7, s[12:15], s31 offen lds
    ds_read_b128 v[124:127], v2 offset:3072
    v_mfma_f32_16x16x32_bf16 v[52:55], v[28:31], a[232:235], v[52:55]
    v_mfma_f32_16x16x32_bf16 v[60:63], v[28:31], a[236:239], v[60:63]
    s_waitcnt vmcnt(13) lgkmcnt(6)
    v_mfma_f32_16x16x32_bf16 v[32:35], v[16:19], a[240:243], v[32:35]
    ds_read_b64_tr_b16 v[24:25], v3 offset:14336
    ds_read_b64_tr_b16 v[26:27], v3 offset:15360
    v_mfma_f32_16x16x32_bf16 v[40:43], v[16:19], a[244:247], v[40:43]
    buffer_load_dwordx4 v8, s[12:15], s31 offen offset:1024 lds
    ds_read_b128 v[128:131], v2 offset:4096
    v_mfma_f32_16x16x32_bf16 v[48:51], v[16:19], a[248:251], v[48:51]
    ds_read_b128 v[132:135], v2 offset:5120
    ds_read_b128 v[136:139], v2 offset:6144
    v_mfma_f32_16x16x32_bf16 v[56:59], v[16:19], a[252:255], v[56:59]
    s_add_u32 m0, s32, 12288
    s_add_u32 s31, s31, 36864
    s_waitcnt lgkmcnt(6)
    v_mfma_f32_16x16x32_bf16 v[36:39], v[20:23], a[240:243], v[36:39]
    ds_read_b64_tr_b16 v[28:29], v4 offset:14336
    ds_read_b64_tr_b16 v[30:31], v4 offset:15360
    v_mfma_f32_16x16x32_bf16 v[44:47], v[20:23], a[244:247], v[44:47]
    buffer_load_dwordx4 v7, s[12:15], s31 offen lds
    ds_read_b128 v[140:143], v2 offset:7168
    v_mfma_f32_16x16x32_bf16 v[52:55], v[20:23], a[248:251], v[52:55]
    v_mfma_f32_16x16x32_bf16 v[60:63], v[20:23], a[252:255], v[60:63]
    s_waitcnt vmcnt(13) lgkmcnt(6)
    v_mfma_f32_16x16x32_bf16 v[32:35], v[24:27], v[112:115], v[32:35]
    ds_read_b64_tr_b16 v[16:17], v3 offset:16384
    ds_read_b64_tr_b16 v[18:19], v3 offset:17408
    v_mfma_f32_16x16x32_bf16 v[40:43], v[24:27], v[116:119], v[40:43]
    buffer_load_dwordx4 v8, s[12:15], s31 offen offset:1024 lds
    v_mfma_f32_16x16x32_bf16 v[48:51], v[24:27], v[120:123], v[48:51]
    v_mfma_f32_16x16x32_bf16 v[56:59], v[24:27], v[124:127], v[56:59]
    s_add_u32 m0, s32, 14336
    s_add_u32 s31, s31, 36864
    s_waitcnt lgkmcnt(3)
    v_mfma_f32_16x16x32_bf16 v[36:39], v[28:31], v[112:115], v[36:39]
    ds_read_b64_tr_b16 v[20:21], v4 offset:16384
    ds_read_b64_tr_b16 v[22:23], v4 offset:17408
    v_mfma_f32_16x16x32_bf16 v[44:47], v[28:31], v[116:119], v[44:47]
    buffer_load_dwordx4 v7, s[12:15], s31 offen lds
    v_mfma_f32_16x16x32_bf16 v[52:55], v[28:31], v[120:123], v[52:55]
    v_mfma_f32_16x16x32_bf16 v[60:63], v[28:31], v[124:127], v[60:63]
    s_waitcnt vmcnt(13) lgkmcnt(2)
    v_mfma_f32_16x16x32_bf16 v[32:35], v[16:19], v[128:131], v[32:35]
    ds_read_b64_tr_b16 v[24:25], v3 offset:0
    ds_read_b64_tr_b16 v[26:27], v3 offset:1024
    v_mfma_f32_16x16x32_bf16 v[40:43], v[16:19], v[132:135], v[40:43]
    buffer_load_dwordx4 v8, s[12:15], s31 offen offset:1024 lds
    v_mfma_f32_16x16x32_bf16 v[48:51], v[16:19], v[136:139], v[48:51]
    v_mfma_f32_16x16x32_bf16 v[56:59], v[16:19], v[140:143], v[56:59]
    s_add_u32 m0, s32, 16384
    s_add_u32 s31, s31, 36864
    s_waitcnt lgkmcnt(2)
    v_mfma_f32_16x16x32_bf16 v[36:39], v[20:23], v[128:131], v[36:39]
    ds_read_b64_tr_b16 v[28:29], v4 offset:0
    ds_read_b64_tr_b16 v[30:31], v4 offset:1024
    v_mfma_f32_16x16x32_bf16 v[44:47], v[20:23], v[132:135], v[44:47]
    buffer_load_dwordx4 v7, s[12:15], s31 offen lds
    v_mfma_f32_16x16x32_bf16 v[52:55], v[20:23], v[136:139], v[52:55]
    v_mfma_f32_16x16x32_bf16 v[60:63], v[20:23], v[140:143], v[60:63]
    s_mov_b32 s38, 2
L_strip_36:
    s_waitcnt vmcnt(13) lgkmcnt(2)
    v_cvt_pk_bf16_f32 v96, v32, v33
    v_cvt_pk_bf16_f32 v97, v34, v35
    v_cvt_pk_bf16_f32 v98, v36, v37
    v_cvt_pk_bf16_f32 v99, v38, v39
    v_mfma_f32_16x16x32_bf16 v[32:35], v[24:27], a[0:3], 0
    ds_read_b64_tr_b16 v[16:17], v3 offset:2048
    ds_read_b64_tr_b16 v[18:19], v3 offset:3072
    v_cvt_pk_bf16_f32 v100, v40, v41
    v_cvt_pk_bf16_f32 v101, v42, v43
    v_cvt_pk_bf16_f32 v102, v44, v45
    v_cvt_pk_bf16_f32 v103, v46, v47
    v_mfma_f32_16x16x32_bf16 v[40:43], v[24:27], a[4:7], 0
    buffer_load_dwordx4 v8, s[12:15], s31 offen offset:1024 lds
    v_cvt_pk_bf16_f32 v104, v48, v49
    v_cvt_pk_bf16_f32 v105, v50, v51
    v_cvt_pk_bf16_f32 v106, v52, v53
    v_cvt_pk_bf16_f32 v107, v54, v55
    v_mfma_f32_16x16x32_bf16 v[48:51], v[24:27], a[8:11], 0
    v_cvt_pk_bf16_f32 v108, v56, v57
    v_cvt_pk_bf16_f32 v109, v58, v59
    v_cvt_pk_bf16_f32 v110, v60, v61
    v_cvt_pk_bf16_f32 v111, v62, v63
    v_mfma_f32_16x16x32_bf16 v[56:59], v[24:27], a[12:15], 0
    s_add_u32 m0, s32, 0
    s_add_u32 s31, s31, 36864
    s_waitcnt lgkmcnt(2)
    v_mfma_f32_16x16x32_bf16 v[36:39], v[28:31], a[0:3], 0
    ds_read_b64_tr_b16 v[20:21], v4 offset:2048
    ds_read_b64_tr_b16 v[22:23], v4 offset:3072
    v_mfma_f32_16x16x32_bf16 v[44:47], v[28:31], a[4:7], 0
    buffer_load_dwordx4 v7, s[12:15], s31 offen lds
    v_mfma_f32_16x16x32_bf16 v[52:55], v[28:31], a[8:11], 0
    v_mfma_f32_16x16x32_bf16 v[60:63], v[28:31], a[12:15], 0
    s_waitcnt vmcnt(13) lgkmcnt(2)
    v_mfma_f32_16x16x32_bf16 v[32:35], v[16:19], a[16:19], v[32:35]
    ds_read_b64_tr_b16 v[24:25], v3 offset:4096
    ds_read_b64_tr_b16 v[26:27], v3 offset:5120
    v_mfma_f32_16x16x32_bf16 v[40:43], v[16:19], a[20:23], v[40:43]
    buffer_load_dwordx4 v8, s[12:15], s31 offen offset:1024 lds
    v_mfma_f32_16x16x32_bf16 v[48:51], v[16:19], a[24:27], v[48:51]
    buffer_store_dwordx4 v[96:99], v1, s[16:19], s54 offen offset:0 sc1
    v_mfma_f32_16x16x32_bf16 v[56:59], v[16:19], a[28:31], v[56:59]
    s_add_u32 m0, s32, 2048
    s_add_u32 s31, s31, 36864
    s_waitcnt lgkmcnt(2)
    v_mfma_f32_16x16x32_bf16 v[36:39], v[20:23], a[16:19], v[36:39]
    ds_read_b64_tr_b16 v[28:29], v4 offset:4096
    ds_read_b64_tr_b16 v[30:31], v4 offset:5120
    v_mfma_f32_16x16x32_bf16 v[44:47], v[20:23], a[20:23], v[44:47]
    buffer_load_dwordx4 v7, s[12:15], s31 offen lds
    v_mfma_f32_16x16x32_bf16 v[52:55], v[20:23], a[24:27], v[52:55]
    buffer_store_dwordx4 v[100:103], v1, s[16:19], s54 offen offset:1024 sc1
    v_mfma_f32_16x16x32_bf16 v[60:63], v[20:23], a[28:31], v[60:63]
    s_waitcnt vmcnt(15) lgkmcnt(2)
    v_mfma_f32_16x16x32_bf16 v[32:35], v[24:27], a[32:35], v[32:35]
    ds_read_b64_tr_b16 v[16:17], v3 offset:6144
    ds_read_b64_tr_b16 v[18:19], v3 offset:7168
    v_mfma_f32_16x16x32_bf16 v[40:43], v[24:27], a[36:39], v[40:43]
    buffer_load_dwordx4 v8, s[12:15], s31 offen offset:1024 lds
    v_mfma_f32_16x16x32_bf16 v[48:51], v[24:27], a[40:43], v[48:51]
    buffer_store_dwordx4 v[104:107], v1, s[16:19], s54 offen offset:2048 sc1
    v_mfma_f32_16x16x32_bf16 v[56:59], v[24:27], a[44:47], v[56:59]
    s_add_u32 m0, s32, 4096
    s_add_u32 s31, s31, 36864
    s_waitcnt lgkmcnt(2)
    v_mfma_f32_16x16x32_bf16 v[36:39], v[28:31], a[32:35], v[36:39]
    ds_read_b64_tr_b16 v[20:21], v4 offset:6144
    ds_read_b64_tr_b16 v[22:23], v4 offset:7168
    v_mfma_f32_16x16x32_bf16 v[44:47], v[28:31], a[36:39], v[44:47]
    buffer_load_dwordx4 v7, s[12:15], s31 offen lds
    v_mfma_f32_16x16x32_bf16 v[52:55], v[28:31], a[40:43], v[52:55]
    buffer_store_dwordx4 v[108:111], v1, s[16:19], s54 offen offset:3072 sc1
    v_mfma_f32_16x16x32_bf16 v[60:63], v[28:31], a[44:47], v[60:63]
    s_waitcnt vmcnt(17) lgkmcnt(2)
    v_mfma_f32_16x16x32_bf16 v[32:35], v[16:19], a[48:51], v[32:35]
    ds_read_b64_tr_b16 v[24:25], v3 offset:8192
    ds_read_b64_tr_b16 v[26:27], v3 offset:9216
    v_mfma_f32_16x16x32_bf16 v[40:43], v[16:19], a[52:55], v[40:43]
    buffer_load_dwordx4 v8, s[12:15], s31 offen offset:1024 lds
    v_mfma_f32_16x16x32_bf16 v[48:51], v[16:19], a[56:59], v[48:51]
    v_mfma_f32_16x16x32_bf16 v[56:59], v[16:19], a[60:63], v[56:59]
    s_add_u32 m0, s32, 6144
    s_add_u32 s31, s31, 36864
    s_waitcnt lgkmcnt(2)
    v_mfma_f32_16x16x32_bf16 v[36:39], v[20:23], a[48:51], v[36:39]
    ds_read_b64_tr_b16 v[28:29], v4 offset:8192
    ds_read_b64_tr_b16 v[30:31], v4 offset:9216
    v_mfma_f32_16x16x32_bf16 v[44:47], v[20:23], a[52:55], v[44:47]
    buffer_load_dwordx4 v7, s[12:15], s31 offen lds
    v_mfma_f32_16x16x32_bf16 v[52:55], v[20:23], a[56:59], v[52:55]
    v_mfma_f32_16x16x32_bf16 v[60:63], v[20:23], a[60:63], v[60:63]
    s_waitcnt vmcnt(17) lgkmcnt(2)
    v_mfma_f32_16x16x32_bf16 v[32:35], v[24:27], a[64:67], v[32:35]
    ds_read_b64_tr_b16 v[16:17], v3 offset:10240
    ds_read_b64_tr_b16 v[18:19], v3 offset:11264
    v_mfma_f32_16x16x32_bf16 v[40:43], v[24:27], a[68:71], v[40:43]
    buffer_load_dwordx4 v8, s[12:15], s31 offen offset:1024 lds
    v_mfma_f32_16x16x32_bf16 v[48:51], v[24:27], a[72:75], v[48:51]
    v_mfma_f32_16x16x32_bf16 v[56:59], v[24:27], a[76:79], v[56:59]
    s_add_u32 m0, s32, 8192
    s_add_u32 s31, s31, 36864
    s_waitcnt lgkmcnt(2)
    v_mfma_f32_16x16x32_bf16 v[36:39], v[28:31], a[64:67], v[36:39]
    ds_read_b64_tr_b16 v[20:21], v4 offset:10240
    ds_read_b64_tr_b16 v[22:23], v4 offset:11264
    v_mfma_f32_16x16x32_bf16 v[44:47], v[28:31], a[68:71], v[44:47]
    buffer_load_dwordx4 v7, s[12:15], s31 offen lds
    v_mfma_f32_16x16x32_bf16 v[52:55], v[28:31], a[72:75], v[52:55]
    v_mfma_f32_16x16x32_bf16 v[60:63], v[28:31], a[76:79], v[60:63]
    s_waitcnt vmcnt(17) lgkmcnt(2)
    v_mfma_f32_16x16x32_bf16 v[32:35], v[16:19], a[80:83], v[32:35]
    ds_read_b64_tr_b16 v[24:25], v3 offset:12288
    ds_read_b64_tr_b16 v[26:27], v3 offset:13312
    v_mfma_f32_16x16x32_bf16 v[40:43], v[16:19], a[84:87], v[40:43]
    buffer_load_dwordx4 v8, s[12:15], s31 offen offset:1024 lds
    v_mfma_f32_16x16x32_bf16 v[48:51], v[16:19], a[88:91], v[48:51]
    v_mfma_f32_16x16x32_bf16 v[56:59], v[16:19], a[92:95], v[56:59]
    s_add_u32 m0, s32, 10240
    s_add_u32 s31, s31, 36864
    s_waitcnt lgkmcnt(2)
    v_mfma_f32_16x16x32_bf16 v[36:39], v[20:23], a[80:83], v[36:39]
    ds_read_b64_tr_b16 v[28:29], v4 offset:12288
    ds_read_b64_tr_b16 v[30:31], v4 offset:13312
    v_mfma_f32_16x16x32_bf16 v[44:47], v[20:23], a[84:87], v[44:47]
    buffer_load_dwordx4 v7, s[12:15], s31 offen lds
    v_mfma_f32_16x16x32_bf16 v[52:55], v[20:23], a[88:91], v[52:55]
    v_mfma_f32_16x16x32_bf16 v[60:63], v[20:23], a[92:95], v[60:63]
    s_waitcnt vmcnt(17) lgkmcnt(2)
    v_mfma_f32_16x16x32_bf16 v[32:35], v[24:27], a[96:99], v[32:35]
    ds_read_b64_tr_b16 v[16:17], v3 offset:14336
    ds_read_b64_tr_b16 v[18:19], v3 offset:15360
    v_mfma_f32_16x16x32_bf16 v[40:43], v[24:27], a[100:103], v[40:43]
    buffer_load_dwordx4 v8, s[12:15], s31 offen offset:1024 lds
    v_mfma_f32_16x16x32_bf16 v[48:51], v[24:27], a[104:107], v[48:51]
    v_mfma_f32_16x16x32_bf16 v[56:59], v[24:27], a[108:111], v[56:59]
    s_add_u32 m0, s32, 12288
    s_add_u32 s31, s31, 36864
    s_waitcnt lgkmcnt(2)
    v_mfma_f32_16x16x32_bf16 v[36:39], v[28:31], a[96:99], v[36:39]
    ds_read_b64_tr_b16 v[20:21], v4 offset:14336
    ds_read_b64_tr_b16 v[22:23], v4 offset:15360
    v_mfma_f32_16x16x32_bf16 v[44:47], v[28:31], a[100:103], v[44:47]
    buffer_load_dwordx4 v7, s[12:15], s31 offen lds
    v_mfma_f32_16x16x32_bf16 v[52:55], v[28:31], a[104:107], v[52:55]
    v_mfma_f32_16x16x32_bf16 v[60:63], v[28:31], a[108:111], v[60:63]
    s_waitcnt vmcnt(17) lgkmcnt(2)
    v_mfma_f32_16x16x32_bf16 v[32:35], v[16:19], a[112:115], v[32:35]
    ds_read_b64_tr_b16 v[24:25], v3 offset:16384
    ds_read_b64_tr_b16 v[26:27], v3 offset:17408
    v_mfma_f32_16x16x32_bf16 v[40:43], v[16:19], a[116:119], v[40:43]
    buffer_load_dwordx4 v8, s[12:15], s31 offen offset:1024 lds
    v_mfma_f32_16x16x32_bf16 v[48:51], v[16:19], a[120:123], v[48:51]
    v_mfma_f32_16x16x32_bf16 v[56:59], v[16:19], a[124:127], v[56:59]
    s_add_u32 m0, s32, 14336
    s_add_u32 s31, s31, 36864
    s_waitcnt lgkmcnt(2)
    v_mfma_f32_16x16x32_bf16 v[36:39], v[20:23], a[112:115], v[36:39]
    ds_read_b64_tr_b16 v[28:29], v4 offset:16384
    ds_read_b64_tr_b16 v[30:31], v4 offset:17408
    v_mfma_f32_16x16x32_bf16 v[44:47], v[20:23], a[116:119], v[44:47]
    buffer_load_dwordx4 v7, s[12:15], s31 offen lds
    v_mfma_f32_16x16x32_bf16 v[52:55], v[20:23], a[120:123], v[52:55]
    v_mfma_f32_16x16x32_bf16 v[60:63], v[20:23], a[124:127], v[60:63]
    s_waitcnt vmcnt(17) lgkmcnt(2)
    v_mfma_f32_16x16x32_bf16 v[32:35], v[24:27], a[128:131], v[32:35]
    ds_read_b64_tr_b16 v[16:17], v3 offset:0
    ds_read_b64_tr_b16 v[18:19], v3 offset:1024
    v_mfma_f32_16x16x32_bf16 v[40:43], v[24:27], a[132:135], v[40:43]
    buffer_load_dwordx4 v8, s[12:15], s31 offen offset:1024 lds
    v_mfma_f32_16x16x32_bf16 v[48:51], v[24:27], a[136:139], v[48:51]
    v_mfma_f32_16x16x32_bf16 v[56:59], v[24:27], a[140:143], v[56:59]
    s_add_u32 m0, s32, 16384
    s_add_u32 s31, s31, 36864
    s_waitcnt lgkmcnt(2)
    v_mfma_f32_16x16x32_bf16 v[36:39], v[28:31], a[128:131], v[36:39]
    ds_read_b64_tr_b16 v[20:21], v4 offset:0
    ds_read_b64_tr_b16 v[22:23], v4 offset:1024
    v_mfma_f32_16x16x32_bf16 v[44:47], v[28:31], a[132:135], v[44:47]
    buffer_load_dwordx4 v7, s[12:15], s31 offen lds
    v_mfma_f32_16x16x32_bf16 v[52:55], v[28:31], a[136:139], v[52:55]
    v_mfma_f32_16x16x32_bf16 v[60:63], v[28:31], a[140:143], v[60:63]
    s_waitcnt vmcnt(15) lgkmcnt(2)
    v_mfma_f32_16x16x32_bf16 v[32:35], v[16:19], a[144:147], v[32:35]
    ds_read_b64_tr_b16 v[24:25], v3 offset:2048
    ds_read_b64_tr_b16 v[26:27], v3 offset:3072
    v_mfma_f32_16x16x32_bf16 v[40:43], v[16:19], a[148:151], v[40:43]
    buffer_load_dwordx4 v8, s[12:15], s31 offen offset:1024 lds
    v_mfma_f32_16x16x32_bf16 v[48:51], v[16:19], a[152:155], v[48:51]
    v_mfma_f32_16x16x32_bf16 v[56:59], v[16:19], a[156:159], v[56:59]
    s_add_u32 m0, s32, 0
    s_mov_b32 s31, s47
    s_waitcnt lgkmcnt(2)
    v_mfma_f32_16x16x32_bf16 v[36:39], v[20:23], a[144:147], v[36:39]
    ds_read_b64_tr_b16 v[28:29], v4 offset:2048
    ds_read_b64_tr_b16 v[30:31], v4 offset:3072
    v_mfma_f32_16x16x32_bf16 v[44:47], v[20:23], a[148:151], v[44:47]
    buffer_load_dwordx4 v7, s[12:15], s31 offen lds
    v_mfma_f32_16x16x32_bf16 v[52:55], v[20:23], a[152:155], v[52:55]
    v_mfma_f32_16x16x32_bf16 v[60:63], v[20:23], a[156:159], v[60:63]
    s_waitcnt vmcnt(13) lgkmcnt(2)
    v_mfma_f32_16x16x32_bf16 v[32:35], v[24:27], a[160:163], v[32:35]
    ds_read_b64_tr_b16 v[16:17], v3 offset:4096
    ds_read_b64_tr_b16 v[18:19], v3 offset:5120
    v_mfma_f32_16x16x32_bf16 v[40:43], v[24:27], a[164:167], v[40:43]
    buffer_load_dwordx4 v8, s[12:15], s31 offen offset:1024 lds
    v_mfma_f32_16x16x32_bf16 v[48:51], v[24:27], a[168:171], v[48:51]
    v_mfma_f32_16x16x32_bf16 v[56:59], v[24:27], a[172:175], v[56:59]
    s_add_u32 m0, s32, 2048
    s_add_u32 s31, s31, 36864
    s_waitcnt lgkmcnt(2)
    v_mfma_f32_16x16x32_bf16 v[36:39], v[28:31], a[160:163], v[36:39]
    ds_read_b64_tr_b16 v[20:21], v4 offset:4096
    ds_read_b64_tr_b16 v[22:23], v4 offset:5120
    v_mfma_f32_16x16x32_bf16 v[44:47], v[28:31], a[164:167], v[44:47]
    buffer_load_dwordx4 v7, s[12:15], s31 offen lds
    v_mfma_f32_16x16x32_bf16 v[52:55], v[28:31], a[168:171], v[52:55]
    v_mfma_f32_16x16x32_bf16 v[60:63], v[28:31], a[172:175], v[60:63]
    s_waitcnt vmcnt(13) lgkmcnt(2)
    v_mfma_f32_16x16x32_bf16 v[32:35], v[16:19], a[176:179], v[32:35]
    ds_read_b64_tr_b16 v[24:25], v3 offset:6144
    ds_read_b64_tr_b16 v[26:27], v3 offset:7168
    v_mfma_f32_16x16x32_bf16 v[40:43], v[16:19], a[180:183], v[40:43]
    buffer_load_dwordx4 v8, s[12:15], s31 offen offset:1024 lds
    v_mfma_f32_16x16x32_bf16 v[48:51], v[16:19], a[184:187], v[48:51]
    v_mfma_f32_16x16x32_bf16 v[56:59], v[16:19], a[188:191], v[56:59]
    s_add_u32 m0, s32, 4096
    s_add_u32 s31, s31, 36864
    s_waitcnt lgkmcnt(2)
    v_mfma_f32_16x16x32_bf16 v[36:39], v[20:23], a[176:179], v[36:39]
    ds_read_b64_tr_b16 v[28:29], v4 offset:6144
    ds_read_b64_tr_b16 v[30:31], v4 offset:7168
    v_mfma_f32_16x16x32_bf16 v[44:47], v[20:23], a[180:183], v[44:47]
    buffer_load_dwordx4 v7, s[12:15], s31 offen lds
    v_mfma_f32_16x16x32_bf16 v[52:55], v[20:23], a[184:187], v[52:55]
    v_mfma_f32_16x16x32_bf16 v[60:63], v[20:23], a[188:191], v[60:63]
    s_waitcnt vmcnt(13) lgkmcnt(2)
    v_mfma_f32_16x16x32_bf16 v[32:35], v[24:27], a[192:195], v[32:35]
    ds_read_b64_tr_b16 v[16:17], v3 offset:8192
    ds_read_b64_tr_b16 v[18:19], v3 offset:9216
    v_mfma_f32_16x16x32_bf16 v[40:43], v[24:27], a[196:199], v[40:43]
    buffer_load_dwordx4 v8, s[12:15], s31 offen offset:1024 lds
    v_mfma_f32_16x16x32_bf16 v[48:51], v[24:27], a[200:203], v[48:51]
    v_mfma_f32_16x16x32_bf16 v[56:59], v[24:27], a[204:207], v[56:59]
    s_add_u32 m0, s32, 6144
    s_add_u32 s31, s31, 36864
    s_waitcnt lgkmcnt(2)
    v_mfma_f32_16x16x32_bf16 v[36:39], v[28:31], a[192:195], v[36:39]
    ds_read_b64_tr_b16 v[20:21], v4 offset:8192
    ds_read_b64_tr_b16 v[22:23], v4 offset:9216
    v_mfma_f32_16x16x32_bf16 v[44:47], v[28:31], a[196:199], v[44:47]
    buffer_load_dwordx4 v7, s[12:15], s31 offen lds
    v_mfma_f32_16x16x32_bf16 v[52:55], v[28:31], a[200:203], v[52:55]
    v_mfma_f32_16x16x32_bf16 v[60:63], v[28:31], a[204:207], v[60:63]
    s_waitcnt vmcnt(13) lgkmcnt(2)
    v_mfma_f32_16x16x32_bf16 v[32:35], v[16:19], a[208:211], v[32:35]
    ds_read_b64_tr_b16 v[24:25], v3 offset:10240
    ds_read_b64_tr_b16 v[26:27], v3 offset:11264
    v_mfma_f32_16x16x32_bf16 v[40:43], v[16:19], a[212:215], v[40:43]
    buffer_load_dwordx4 v8, s[12:15], s31 offen offset:1024 lds
    v_mfma_f32_16x16x32_bf16 v[48:51], v[16:19], a[216:219], v[48:51]
    v_mfma_f32_16x16x32_bf16 v[56:59], v[16:19], a[220:223], v[56:59]
    s_add_u32 m0, s32, 8192
    s_add_u32 s31, s31, 36864
    s_waitcnt lgkmcnt(2)
    v_mfma_f32_16x16x32_bf16 v[36:39], v[20:23], a[208:211], v[36:39]
    ds_read_b64_tr_b16 v[28:29], v4 offset:10240
    ds_read_b64_tr_b16 v[30:31], v4 offset:11264
    v_mfma_f32_16x16x32_bf16 v[44:47], v[20:23], a[212:215], v[44:47]
    buffer_load_dwordx4 v7, s[12:15], s31 offen lds
    v_mfma_f32_16x16x32_bf16 v[52:55], v[20:23], a[216:219], v[52:55]
    v_mfma_f32_16x16x32_bf16 v[60:63], v[20:23], a[220:223], v[60:63]
    s_waitcnt vmcnt(13) lgkmcnt(2)
    v_mfma_f32_16x16x32_bf16 v[32:35], v[24:27], a[224:227], v[32:35]
    ds_read_b64_tr_b16 v[16:17], v3 offset:12288
    ds_read_b64_tr_b16 v[18:19], v3 offset:13312
    v_mfma_f32_16x16x32_bf16 v[40:43], v[24:27], a[228:231], v[40:43]
    buffer_load_dwordx4 v8, s[12:15], s31 offen offset:1024 lds
    s_mov_b32 s47, s48
    v_mfma_f32_16x16x32_bf16 v[48:51], v[24:27], a[232:235], v[48:51]
    s_mov_b32 s48, s49
    s_mov_b32 s54, s55
    v_mfma_f32_16x16x32_bf16 v[56:59], v[24:27], a[236:239], v[56:59]
    s_add_u32 m0, s32, 10240
    s_add_u32 s31, s31, 36864
    s_waitcnt lgkmcnt(2)
    v_mfma_f32_16x16x32_bf16 v[36:39], v[28:31], a[224:227], v[36:39]
    ds_read_b64_tr_b16 v[20:21], v4 offset:12288
    ds_read_b64_tr_b16 v[22:23], v4 offset:13312
    v_mfma_f32_16x16x32_bf16 v[44:47], v[28:31], a[228:231], v[44:47]
    buffer_load_dwordx4 v7, s[12:15], s31 offen lds
    s_mov_b32 s55, s56
    v_mfma_f32_16x16x32_bf16 v[52:55], v[28:31], a[232:235], v[52:55]
    s_mov_b32 s56, s57
    v_mfma_f32_16x16x32_bf16 v[60:63], v[28:31], a[236:239], v[60:63]
    s_waitcnt vmcnt(13) lgkmcnt(2)
    v_mfma_f32_16x16x32_bf16 v[32:35], v[16:19], a[240:243], v[32:35]
    ds_read_b64_tr_b16 v[24:25], v3 offset:14336
    ds_read_b64_tr_b16 v[26:27], v3 offset:15360
    v_mfma_f32_16x16x32_bf16 v[40:43], v[16:19], a[244:247], v[40:43]
    buffer_load_dwordx4 v8, s[12:15], s31 offen offset:1024 lds
    v_mfma_f32_16x16x32_bf16 v[48:51], v[16:19], a[248:251], v[48:51]
    v_mfma_f32_16x16x32_bf16 v[56:59], v[16:19], a[252:255], v[56:59]
    s_add_u32 m0, s32, 12288
    s_add_u32 s31, s31, 36864
    s_waitcnt lgkmcnt(2)
    v_mfma_f32_16x16x32_bf16 v[36:39], v[20:23], a[240:243], v[36:39]
    ds_read_b64_tr_b16 v[28:29], v4 offset:14336
    ds_read_b64_tr_b16 v[30:31], v4 offset:15360
    v_mfma_f32_16x16x32_bf16 v[44:47], v[20:23], a[244:247], v[44:47]
    buffer_load_dwordx4 v7, s[12:15], s31 offen lds
    v_mfma_f32_16x16x32_bf16 v[52:55], v[20:23], a[248:251], v[52:55]
    v_mfma_f32_16x16x32_bf16 v[60:63], v[20:23], a[252:255], v[60:63]
    s_waitcnt vmcnt(13) lgkmcnt(2)
    v_mfma_f32_16x16x32_bf16 v[32:35], v[24:27], v[112:115], v[32:35]
    ds_read_b64_tr_b16 v[16:17], v3 offset:16384
    ds_read_b64_tr_b16 v[18:19], v3 offset:17408
    v_mfma_f32_16x16x32_bf16 v[40:43], v[24:27], v[116:119], v[40:43]
    buffer_load_dwordx4 v8, s[12:15], s31 offen offset:1024 lds
    v_mfma_f32_16x16x32_bf16 v[48:51], v[24:27], v[120:123], v[48:51]
    v_mfma_f32_16x16x32_bf16 v[56:59], v[24:27], v[124:127], v[56:59]
    s_add_u32 m0, s32, 14336
    s_add_u32 s31, s31, 36864
    s_waitcnt lgkmcnt(2)
    v_mfma_f32_16x16x32_bf16 v[36:39], v[28:31], v[112:115], v[36:39]
    ds_read_b64_tr_b16 v[20:21], v4 offset:16384
    ds_read_b64_tr_b16 v[22:23], v4 offset:17408
    v_mfma_f32_16x16x32_bf16 v[44:47], v[28:31], v[116:119], v[44:47]
    buffer_load_dwordx4 v7, s[12:15], s31 offen lds
    v_mfma_f32_16x16x32_bf16 v[52:55], v[28:31], v[120:123], v[52:55]
    v_mfma_f32_16x16x32_bf16 v[60:63], v[28:31], v[124:127], v[60:63]
    s_waitcnt vmcnt(13) lgkmcnt(2)
    v_mfma_f32_16x16x32_bf16 v[32:35], v[16:19], v[128:131], v[32:35]
    ds_read_b64_tr_b16 v[24:25], v3 offset:0
    ds_read_b64_tr_b16 v[26:27], v3 offset:1024
    v_mfma_f32_16x16x32_bf16 v[40:43], v[16:19], v[132:135], v[40:43]
    buffer_load_dwordx4 v8, s[12:15], s31 offen offset:1024 lds
    v_mfma_f32_16x16x32_bf16 v[48:51], v[16:19], v[136:139], v[48:51]
    v_mfma_f32_16x16x32_bf16 v[56:59], v[16:19], v[140:143], v[56:59]
    s_add_u32 m0, s32, 16384
    s_add_u32 s31, s31, 36864
    s_waitcnt lgkmcnt(2)
    v_mfma_f32_16x16x32_bf16 v[36:39], v[20:23], v[128:131], v[36:39]
    ds_read_b64_tr_b16 v[28:29], v4 offset:0
    ds_read_b64_tr_b16 v[30:31], v4 offset:1024
    v_mfma_f32_16x16x32_bf16 v[44:47], v[20:23], v[132:135], v[44:47]
    buffer_load_dwordx4 v7, s[12:15], s31 offen lds
    v_mfma_f32_16x16x32_bf16 v[52:55], v[20:23], v[136:139], v[52:55]
    v_mfma_f32_16x16x32_bf16 v[60:63], v[20:23], v[140:143], v[60:63]
    s_sub_u32 s38, s38, 1
    s_cbranch_scc0 L_strip_36
    s_bitcmp1_b32 s30, 0
    s_cbranch_scc1 L_odd_37
    s_waitcnt vmcnt(13) lgkmcnt(2)
    v_cvt_pk_bf16_f32 v96, v32, v33
    v_cvt_pk_bf16_f32 v97, v34, v35
    v_cvt_pk_bf16_f32 v98, v36, v37
    v_cvt_pk_bf16_f32 v99, v38, v39
    v_mfma_f32_16x16x32_bf16 v[64:67], v[24:27], a[0:3], 0
    ds_read_b64_tr_b16 v[16:17], v3 offset:2048
    ds_read_b64_tr_b16 v[18:19], v3 offset:3072
    v_cvt_pk_bf16_f32 v100, v40, v41
    v_cvt_pk_bf16_f32 v101, v42, v43
    v_cvt_pk_bf16_f32 v102, v44, v45
    v_cvt_pk_bf16_f32 v103, v46, v47
    v_mfma_f32_16x16x32_bf16 v[72:75], v[24:27], a[4:7], 0
    buffer_load_dwordx4 v8, s[12:15], s31 offen offset:1024 lds
    v_cvt_pk_bf16_f32 v104, v48, v49
    v_cvt_pk_bf16_f32 v105, v50, v51
    v_cvt_pk_bf16_f32 v106, v52, v53
    v_cvt_pk_bf16_f32 v107, v54, v55
    v_mfma_f32_16x16x32_bf16 v[80:83], v[24:27], a[8:11], 0
    v_cvt_pk_bf16_f32 v108, v56, v57
    v_cvt_pk_bf16_f32 v109, v58, v59
    v_cvt_pk_bf16_f32 v110, v60, v61
    v_cvt_pk_bf16_f32 v111, v62, v63
    v_mfma_f32_16x16x32_bf16 v[88:91], v[24:27], a[12:15], 0
    s_waitcnt lgkmcnt(2)
    v_mfma_f32_16x16x32_bf16 v[68:71], v[28:31], a[0:3], 0
    ds_read_b64_tr_b16 v[20:21], v4 offset:2048
    ds_read_b64_tr_b16 v[22:23], v4 offset:3072
    v_mfma_f32_16x16x32_bf16 v[76:79], v[28:31], a[4:7], 0
    v_mfma_f32_16x16x32_bf16 v[84:87], v[28:31], a[8:11], 0
    v_mfma_f32_16x16x32_bf16 v[92:95], v[28:31], a[12:15], 0
    s_waitcnt vmcnt(12) lgkmcnt(2)
    v_mfma_f32_16x16x32_bf16 v[64:67], v[16:19], a[16:19], v[64:67]
    ds_read_b64_tr_b16 v[24:25], v3 offset:4096
    ds_read_b64_tr_b16 v[26:27], v3 offset:5120
    v_mfma_f32_16x16x32_bf16 v[72:75], v[16:19], a[20:23], v[72:75]
    v_mfma_f32_16x16x32_bf16 v[80:83], v[16:19], a[24:27], v[80:83]
    buffer_store_dwordx4 v[96:99], v1, s[16:19], s54 offen offset:0 sc1
    v_mfma_f32_16x16x32_bf16 v[88:91], v[16:19], a[28:31], v[88:91]
    s_waitcnt lgkmcnt(2)
    v_mfma_f32_16x16x32_bf16 v[68:71], v[20:23], a[16:19], v[68:71]
    ds_read_b64_tr_b16 v[28:29], v4 offset:4096
    ds_read_b64_tr_b16 v[30:31], v4 offset:5120
    v_mfma_f32_16x16x32_bf16 v[76:79], v[20:23], a[20:23], v[76:79]
    v_mfma_f32_16x16x32_bf16 v[84:87], v[20:23], a[24:27], v[84:87]
    buffer_store_dwordx4 v[100:103], v1, s[16:19], s54 offen offset:1024 sc1
    v_mfma_f32_16x16x32_bf16 v[92:95], v[20:23], a[28:31], v[92:95]
    s_waitcnt vmcnt(12) lgkmcnt(2)
    v_mfma_f32_16x16x32_bf16 v[64:67], v[24:27], a[32:35], v[64:67]
    ds_read_b64_tr_b16 v[16:17], v3 offset:6144
    ds_read_b64_tr_b16 v[18:19], v3 offset:7168
    v_mfma_f32_16x16x32_bf16 v[72:75], v[24:27], a[36:39], v[72:75]
    v_mfma_f32_16x16x32_bf16 v[80:83], v[24:27], a[40:43], v[80:83]
    buffer_store_dwordx4 v[104:107], v1, s[16:19], s54 offen offset:2048 sc1
    v_mfma_f32_16x16x32_bf16 v[88:91], v[24:27], a[44:47], v[88:91]
    s_waitcnt lgkmcnt(2)
    v_mfma_f32_16x16x32_bf16 v[68:71], v[28:31], a[32:35], v[68:71]
    ds_read_b64_tr_b16 v[20:21], v4 offset:6144
    ds_read_b64_tr_b16 v[22:23], v4 offset:7168
    v_mfma_f32_16x16x32_bf16 v[76:79], v[28:31], a[36:39], v[76:79]
    v_mfma_f32_16x16x32_bf16 v[84:87], v[28:31], a[40:43], v[84:87]
    buffer_store_dwordx4 v[108:111], v1, s[16:19], s54 offen offset:3072 sc1
    v_mfma_f32_16x16x32_bf16 v[92:95], v[28:31], a[44:47], v[92:95]
    s_waitcnt vmcnt(12) lgkmcnt(2)
    v_mfma_f32_16x16x32_bf16 v[64:67], v[16:19], a[48:51], v[64:67]
    ds_read_b64_tr_b16 v[24:25], v3 offset:8192
    ds_read_b64_tr_b16 v[26:27], v3 offset:9216
    v_mfma_f32_16x16x32_bf16 v[72:75], v[16:19], a[52:55], v[72:75]
    v_lshlrev_b32 v144, 16, v184
    v_mfma_f32_16x16x32_bf16 v[80:83], v[16:19], a[56:59], v[80:83]
    v_and_b32 v145, 0xffff0000, v184
    v_add_f32 v144, v144, v204
    v_mfma_f32_16x16x32_bf16 v[88:91], v[16:19], a[60:63], v[88:91]
    s_waitcnt lgkmcnt(2)
    v_mfma_f32_16x16x32_bf16 v[68:71], v[20:23], a[48:51], v[68:71]
    ds_read_b64_tr_b16 v[28:29], v4 offset:8192
    ds_read_b64_tr_b16 v[30:31], v4 offset:9216
    v_mfma_f32_16x16x32_bf16 v[76:79], v[20:23], a[52:55], v[76:79]
    v_add_f32 v145, v145, v204
    v_mfma_f32_16x16x32_bf16 v[84:87], v[20:23], a[56:59], v[84:87]
    v_lshlrev_b32 v146, 16, v185
    v_and_b32 v147, 0xffff0000, v185
    v_mfma_f32_16x16x32_bf16 v[92:95], v[20:23], a[60:63], v[92:95]
    v_add_f32 v146, v146, v204
    v_add_f32 v147, v147, v204
    s_waitcnt vmcnt(10) lgkmcnt(2)
    v_mfma_f32_16x16x32_bf16 v[64:67], v[24:27], a[64:67], v[64:67]
    ds_read_b64_tr_b16 v[16:17], v3 offset:10240
    ds_read_b64_tr_b16 v[18:19], v3 offset:11264
    v_mfma_f32_16x16x32_bf16 v[72:75], v[24:27], a[68:71], v[72:75]
    v_lshlrev_b32 v148, 16, v186
    v_mfma_f32_16x16x32_bf16 v[80:83], v[24:27], a[72:75], v[80:83]
    v_and_b32 v149, 0xffff0000, v186
    v_add_f32 v148, v148, v204
    v_mfma_f32_16x16x32_bf16 v[88:91], v[24:27], a[76:79], v[88:91]
    s_waitcnt lgkmcnt(2)
    v_mfma_f32_16x16x32_bf16 v[68:71], v[28:31], a[64:67], v[68:71]
    ds_read_b64_tr_b16 v[20:21], v4 offset:10240
    ds_read_b64_tr_b16 v[22:23], v4 offset:11264
    v_mfma_f32_16x16x32_bf16 v[76:79], v[28:31], a[68:71], v[76:79]
    v_add_f32 v149, v149, v204
    v_mfma_f32_16x16x32_bf16 v[84:87], v[28:31], a[72:75], v[84:87]
    v_lshlrev_b32 v150, 16, v187
    v_and_b32 v151, 0xffff0000, v187
    v_mfma_f32_16x16x32_bf16 v[92:95], v[28:31], a[76:79], v[92:95]
    v_add_f32 v150, v150, v204
    v_add_f32 v151, v151, v204
    s_waitcnt vmcnt(8) lgkmcnt(2)
    v_mfma_f32_16x16x32_bf16 v[64:67], v[16:19], a[80:83], v[64:67]
    ds_read_b64_tr_b16 v[24:25], v3 offset:12288
    ds_read_b64_tr_b16 v[26:27], v3 offset:13312
    v_mfma_f32_16x16x32_bf16 v[72:75], v[16:19], a[84:87], v[72:75]
    v_lshlrev_b32 v152, 16, v192
    v_mfma_f32_16x16x32_bf16 v[80:83], v[16:19], a[88:91], v[80:83]
    v_and_b32 v153, 0xffff0000, v192
    v_add_f32 v152, v152, v205
    v_mfma_f32_16x16x32_bf16 v[88:91], v[16:19], a[92:95], v[88:91]
    s_waitcnt lgkmcnt(2)
    v_mfma_f32_16x16x32_bf16 v[68:71], v[20:23], a[80:83], v[68:71]
    ds_read_b64_tr_b16 v[28:29], v4 offset:12288
    ds_read_b64_tr_b16 v[30:31], v4 offset:13312
    v_mfma_f32_16x16x32_bf16 v[76:79], v[20:23], a[84:87], v[76:79]
    v_add_f32 v153, v153, v205
    v_mfma_f32_16x16x32_bf16 v[84:87], v[20:23], a[88:91], v[84:87]
    v_lshlrev_b32 v154, 16, v193
    v_and_b32 v155, 0xffff0000, v193
    v_mfma_f32_16x16x32_bf16 v[92:95], v[20:23], a[92:95], v[92:95]
    v_add_f32 v154, v154, v205
    v_add_f32 v155, v155, v205
    s_waitcnt vmcnt(6) lgkmcnt(2)
    v_mfma_f32_16x16x32_bf16 v[64:67], v[24:27], a[96:99], v[64:67]
    ds_read_b64_tr_b16 v[16:17], v3 offset:14336
    ds_read_b64_tr_b16 v[18:19], v3 offset:15360
    v_mfma_f32_16x16x32_bf16 v[72:75], v[24:27], a[100:103], v[72:75]
    v_lshlrev_b32 v156, 16, v194
    v_mfma_f32_16x16x32_bf16 v[80:83], v[24:27], a[104:107], v[80:83]
    v_and_b32 v157, 0xffff0000, v194
    v_add_f32 v156, v156, v205
    v_mfma_f32_16x16x32_bf16 v[88:91], v[24:27], a[108:111], v[88:91]
    s_waitcnt lgkmcnt(2)
    v_mfma_f32_16x16x32_bf16 v[68:71], v[28:31], a[96:99], v[68:71]
    ds_read_b64_tr_b16 v[20:21], v4 offset:14336
    ds_read_b64_tr_b16 v[22:23], v4 offset:15360
    v_mfma_f32_16x16x32_bf16 v[76:79], v[28:31], a[100:103], v[76:79]
    v_add_f32 v157, v157, v205
    v_mfma_f32_16x16x32_bf16 v[84:87], v[28:31], a[104:107], v[84:87]
    v_lshlrev_b32 v158, 16, v195
    v_and_b32 v159, 0xffff0000, v195
    v_mfma_f32_16x16x32_bf16 v[92:95], v[28:31], a[108:111], v[92:95]
    v_add_f32 v158, v158, v205
    v_add_f32 v159, v159, v205
    s_waitcnt vmcnt(4) lgkmcnt(2)
    v_mfma_f32_16x16x32_bf16 v[64:67], v[16:19], a[112:115], v[64:67]
    ds_read_b64_tr_b16 v[24:25], v3 offset:16384
    ds_read_b64_tr_b16 v[26:27], v3 offset:17408
    v_mfma_f32_16x16x32_bf16 v[72:75], v[16:19], a[116:119], v[72:75]
    v_lshlrev_b32 v160, 16, v200
    v_mfma_f32_16x16x32_bf16 v[80:83], v[16:19], a[120:123], v[80:83]
    v_and_b32 v161, 0xffff0000, v200
    v_add_f32 v160, v160, v206
    v_mfma_f32_16x16x32_bf16 v[88:91], v[16:19], a[124:127], v[88:91]
    s_waitcnt lgkmcnt(2)
    v_mfma_f32_16x16x32_bf16 v[68:71], v[20:23], a[112:115], v[68:71]
    ds_read_b64_tr_b16 v[28:29], v4 offset:16384
    ds_read_b64_tr_b16 v[30:31], v4 offset:17408
    v_mfma_f32_16x16x32_bf16 v[76:79], v[20:23], a[116:119], v[76:79]
    v_add_f32 v161, v161, v206
    v_mfma_f32_16x16x32_bf16 v[84:87], v[20:23], a[120:123], v[84:87]
    v_lshlrev_b32 v162, 16, v201
    v_and_b32 v163, 0xffff0000, v201
    v_mfma_f32_16x16x32_bf16 v[92:95], v[20:23], a[124:127], v[92:95]
    v_add_f32 v162, v162, v206
    v_add_f32 v163, v163, v206
    s_waitcnt lgkmcnt(2)
    v_mfma_f32_16x16x32_bf16 v[64:67], v[24:27], a[128:131], v[64:67]
    v_lshlrev_b32 v164, 16, v202
    v_and_b32 v165, 0xffff0000, v202
    v_mfma_f32_16x16x32_bf16 v[72:75], v[24:27], a[132:135], v[72:75]
    v_add_f32 v164, v164, v206
    v_mfma_f32_16x16x32_bf16 v[80:83], v[24:27], a[136:139], v[80:83]
    v_add_f32 v165, v165, v206
    v_lshlrev_b32 v166, 16, v203
    v_mfma_f32_16x16x32_bf16 v[88:91], v[24:27], a[140:143], v[88:91]
    s_waitcnt lgkmcnt(0)
    v_mfma_f32_16x16x32_bf16 v[68:71], v[28:31], a[128:131], v[68:71]
    v_and_b32 v167, 0xffff0000, v203
    v_add_f32 v166, v166, v206
    v_mfma_f32_16x16x32_bf16 v[76:79], v[28:31], a[132:135], v[76:79]
    v_add_f32 v167, v167, v206
    v_mfma_f32_16x16x32_bf16 v[84:87], v[28:31], a[136:139], v[84:87]
    v_mfma_f32_16x16x32_bf16 v[92:95], v[28:31], a[140:143], v[92:95]
    s_branch L_join_38
L_odd_37:
    s_waitcnt vmcnt(13) lgkmcnt(2)
    v_cvt_pk_bf16_f32 v96, v32, v33
    v_cvt_pk_bf16_f32 v97, v34, v35
    v_cvt_pk_bf16_f32 v98, v36, v37
    v_cvt_pk_bf16_f32 v99, v38, v39
    v_mfma_f32_16x16x32_bf16 v[64:67], v[24:27], a[152:155], 0
    ds_read_b64_tr_b16 v[16:17], v3 offset:2048
    ds_read_b64_tr_b16 v[18:19], v3 offset:3072
    v_cvt_pk_bf16_f32 v100, v40, v41
    v_cvt_pk_bf16_f32 v101, v42, v43
    v_cvt_pk_bf16_f32 v102, v44, v45
    v_cvt_pk_bf16_f32 v103, v46, v47
    v_mfma_f32_16x16x32_bf16 v[72:75], v[24:27], a[156:159], 0
    buffer_load_dwordx4 v8, s[12:15], s31 offen offset:1024 lds
    v_cvt_pk_bf16_f32 v104, v48, v49
    v_cvt_pk_bf16_f32 v105, v50, v51
    v_cvt_pk_bf16_f32 v106, v52, v53
    v_cvt_pk_bf16_f32 v107, v54, v55
    v_mfma_f32_16x16x32_bf16 v[80:83], v[24:27], a[144:147], 0
    v_cvt_pk_bf16_f32 v108, v56, v57
    v_cvt_pk_bf16_f32 v109, v58, v59
    v_cvt_pk_bf16_f32 v110, v60, v61
    v_cvt_pk_bf16_f32 v111, v62, v63
    v_mfma_f32_16x16x32_bf16 v[88:91], v[24:27], a[148:151], 0
    s_waitcnt lgkmcnt(2)
    v_mfma_f32_16x16x32_bf16 v[68:71], v[28:31], a[152:155], 0
    ds_read_b64_tr_b16 v[20:21], v4 offset:2048
    ds_read_b64_tr_b16 v[22:23], v4 offset:3072
    v_mfma_f32_16x16x32_bf16 v[76:79], v[28:31], a[156:159], 0
    v_mfma_f32_16x16x32_bf16 v[84:87], v[28:31], a[144:147], 0
    v_mfma_f32_16x16x32_bf16 v[92:95], v[28:31], a[148:151], 0
    s_waitcnt vmcnt(12) lgkmcnt(2)
    v_mfma_f32_16x16x32_bf16 v[64:67], v[16:19], a[168:171], v[64:67]
    ds_read_b64_tr_b16 v[24:25], v3 offset:4096
    ds_read_b64_tr_b16 v[26:27], v3 offset:5120
    v_mfma_f32_16x16x32_bf16 v[72:75], v[16:19], a[172:175], v[72:75]
    v_mfma_f32_16x16x32_bf16 v[80:83], v[16:19], a[160:163], v[80:83]
    buffer_store_dwordx4 v[96:99], v1, s[16:19], s54 offen offset:0 sc1
    v_mfma_f32_16x16x32_bf16 v[88:91], v[16:19], a[164:167], v[88:91]
    s_waitcnt lgkmcnt(2)
    v_mfma_f32_16x16x32_bf16 v[68:71], v[20:23], a[168:171], v[68:71]
    ds_read_b64_tr_b16 v[28:29], v4 offset:4096
    ds_read_b64_tr_b16 v[30:31], v4 offset:5120
    v_mfma_f32_16x16x32_bf16 v[76:79], v[20:23], a[172:175], v[76:79]
    v_mfma_f32_16x16x32_bf16 v[84:87], v[20:23], a[160:163], v[84:87]
    buffer_store_dwordx4 v[100:103], v1, s[16:19], s54 offen offset:1024 sc1
    v_mfma_f32_16x16x32_bf16 v[92:95], v[20:23], a[164:167], v[92:95]
    s_waitcnt vmcnt(12) lgkmcnt(2)
    v_mfma_f32_16x16x32_bf16 v[64:67], v[24:27], a[184:187], v[64:67]
    ds_read_b64_tr_b16 v[16:17], v3 offset:6144
    ds_read_b64_tr_b16 v[18:19], v3 offset:7168
    v_mfma_f32_16x16x32_bf16 v[72:75], v[24:27], a[188:191], v[72:75]
    v_mfma_f32_16x16x32_bf16 v[80:83], v[24:27], a[176:179], v[80:83]
    buffer_store_dwordx4 v[104:107], v1, s[16:19], s54 offen offset:2048 sc1
    v_mfma_f32_16x16x32_bf16 v[88:91], v[24:27], a[180:183], v[88:91]
    s_waitcnt lgkmcnt(2)
    v_mfma_f32_16x16x32_bf16 v[68:71], v[28:31], a[184:187], v[68:71]
    ds_read_b64_tr_b16 v[20:21], v4 offset:6144
    ds_read_b64_tr_b16 v[22:23], v4 offset:7168
    v_mfma_f32_16x16x32_bf16 v[76:79], v[28:31], a[188:191], v[76:79]
    v_mfma_f32_16x16x32_bf16 v[84:87], v[28:31], a[176:179], v[84:87]
    buffer_store_dwordx4 v[108:111], v1, s[16:19], s54 offen offset:3072 sc1
    v_mfma_f32_16x16x32_bf16 v[92:95], v[28:31], a[180:183], v[92:95]
    s_waitcnt vmcnt(12) lgkmcnt(2)
    v_mfma_f32_16x16x32_bf16 v[64:67], v[16:19], a[200:203], v[64:67]
    ds_read_b64_tr_b16 v[24:25], v3 offset:8192
    ds_read_b64_tr_b16 v[26:27], v3 offset:9216
    v_mfma_f32_16x16x32_bf16 v[72:75], v[16:19], a[204:207], v[72:75]
    v_lshlrev_b32 v144, 16, v184
    v_mfma_f32_16x16x32_bf16 v[80:83], v[16:19], a[192:195], v[80:83]
    v_and_b32 v145, 0xffff0000, v184
    v_add_f32 v144, v144, v204
    v_mfma_f32_16x16x32_bf16 v[88:91], v[16:19], a[196:199], v[88:91]
    s_waitcnt lgkmcnt(2)
    v_mfma_f32_16x16x32_bf16 v[68:71], v[20:23], a[200:203], v[68:71]
    ds_read_b64_tr_b16 v[28:29], v4 offset:8192
    ds_read_b64_tr_b16 v[30:31], v4 offset:9216
    v_mfma_f32_16x16x32_bf16 v[76:79], v[20:23], a[204:207], v[76:79]
    v_add_f32 v145, v145, v204
    v_mfma_f32_16x16x32_bf16 v[84:87], v[20:23], a[192:195], v[84:87]
    v_lshlrev_b32 v146, 16, v185
    v_and_b32 v147, 0xffff0000, v185
    v_mfma_f32_16x16x32_bf16 v[92:95], v[20:23], a[196:199], v[92:95]
    v_add_f32 v146, v146, v204
    v_add_f32 v147, v147, v204
    s_waitcnt vmcnt(10) lgkmcnt(2)
    v_mfma_f32_16x16x32_bf16 v[64:67], v[24:27], a[216:219], v[64:67]
    ds_read_b64_tr_b16 v[16:17], v3 offset:10240
    ds_read_b64_tr_b16 v[18:19], v3 offset:11264
    v_mfma_f32_16x16x32_bf16 v[72:75], v[24:27], a[220:223], v[72:75]
    v_lshlrev_b32 v148, 16, v186
    v_mfma_f32_16x16x32_bf16 v[80:83], v[24:27], a[208:211], v[80:83]
    v_and_b32 v149, 0xffff0000, v186
    v_add_f32 v148, v148, v204
    v_mfma_f32_16x16x32_bf16 v[88:91], v[24:27], a[212:215], v[88:91]
    s_waitcnt lgkmcnt(2)
    v_mfma_f32_16x16x32_bf16 v[68:71], v[28:31], a[216:219], v[68:71]
    ds_read_b64_tr_b16 v[20:21], v4 offset:10240
    ds_read_b64_tr_b16 v[22:23], v4 offset:11264
    v_mfma_f32_16x16x32_bf16 v[76:79], v[28:31], a[220:223], v[76:79]
    v_add_f32 v149, v149, v204
    v_mfma_f32_16x16x32_bf16 v[84:87], v[28:31], a[208:211], v[84:87]
    v_lshlrev_b32 v150, 16, v187
    v_and_b32 v151, 0xffff0000, v187
    v_mfma_f32_16x16x32_bf16 v[92:95], v[28:31], a[212:215], v[92:95]
    v_add_f32 v150, v150, v204
    v_add_f32 v151, v151, v204
    s_waitcnt vmcnt(8) lgkmcnt(2)
    v_mfma_f32_16x16x32_bf16 v[64:67], v[16:19], a[232:235], v[64:67]
    ds_read_b64_tr_b16 v[24:25], v3 offset:12288
    ds_read_b64_tr_b16 v[26:27], v3 offset:13312
    v_mfma_f32_16x16x32_bf16 v[72:75], v[16:19], a[236:239], v[72:75]
    v_lshlrev_b32 v152, 16, v192
    v_mfma_f32_16x16x32_bf16 v[80:83], v[16:19], a[224:227], v[80:83]
    v_and_b32 v153, 0xffff0000, v192
    v_add_f32 v152, v152, v205
    v_mfma_f32_16x16x32_bf16 v[88:91], v[16:19], a[228:231], v[88:91]
    s_waitcnt lgkmcnt(2)
    v_mfma_f32_16x16x32_bf16 v[68:71], v[20:23], a[232:235], v[68:71]
    ds_read_b64_tr_b16 v[28:29], v4 offset:12288
    ds_read_b64_tr_b16 v[30:31], v4 offset:13312
    v_mfma_f32_16x16x32_bf16 v[76:79], v[20:23], a[236:239], v[76:79]
    v_add_f32 v153, v153, v205
    v_mfma_f32_16x16x32_bf16 v[84:87], v[20:23], a[224:227], v[84:87]
    v_lshlrev_b32 v154, 16, v193
    v_and_b32 v155, 0xffff0000, v193
    v_mfma_f32_16x16x32_bf16 v[92:95], v[20:23], a[228:231], v[92:95]
    v_add_f32 v154, v154, v205
    v_add_f32 v155, v155, v205
    s_waitcnt vmcnt(6) lgkmcnt(2)
    v_mfma_f32_16x16x32_bf16 v[64:67], v[24:27], a[248:251], v[64:67]
    ds_read_b64_tr_b16 v[16:17], v3 offset:14336
    ds_read_b64_tr_b16 v[18:19], v3 offset:15360
    v_mfma_f32_16x16x32_bf16 v[72:75], v[24:27], a[252:255], v[72:75]
    v_lshlrev_b32 v156, 16, v194
    v_mfma_f32_16x16x32_bf16 v[80:83], v[24:27], a[240:243], v[80:83]
    v_and_b32 v157, 0xffff0000, v194
    v_add_f32 v156, v156, v205
    v_mfma_f32_16x16x32_bf16 v[88:91], v[24:27], a[244:247], v[88:91]
    s_waitcnt lgkmcnt(2)
    v_mfma_f32_16x16x32_bf16 v[68:71], v[28:31], a[248:251], v[68:71]
    ds_read_b64_tr_b16 v[20:21], v4 offset:14336
    ds_read_b64_tr_b16 v[22:23], v4 offset:15360
    v_mfma_f32_16x16x32_bf16 v[76:79], v[28:31], a[252:255], v[76:79]
    v_add_f32 v157, v157, v205
    v_mfma_f32_16x16x32_bf16 v[84:87], v[28:31], a[240:243], v[84:87]
    v_lshlrev_b32 v158, 16, v195
    v_and_b32 v159, 0xffff0000, v195
    v_mfma_f32_16x16x32_bf16 v[92:95], v[28:31], a[244:247], v[92:95]
    v_add_f32 v158, v158, v205
    v_add_f32 v159, v159, v205
    s_waitcnt vmcnt(4) lgkmcnt(2)
    v_mfma_f32_16x16x32_bf16 v[64:67], v[16:19], v[120:123], v[64:67]
    ds_read_b64_tr_b16 v[24:25], v3 offset:16384
    ds_read_b64_tr_b16 v[26:27], v3 offset:17408
    v_mfma_f32_16x16x32_bf16 v[72:75], v[16:19], v[124:127], v[72:75]
    v_lshlrev_b32 v160, 16, v200
    v_mfma_f32_16x16x32_bf16 v[80:83], v[16:19], v[112:115], v[80:83]
    v_and_b32 v161, 0xffff0000, v200
    v_add_f32 v160, v160, v206
    v_mfma_f32_16x16x32_bf16 v[88:91], v[16:19], v[116:119], v[88:91]
    s_waitcnt lgkmcnt(2)
    v_mfma_f32_16x16x32_bf16 v[68:71], v[20:23], v[120:123], v[68:71]
    ds_read_b64_tr_b16 v[28:29], v4 offset:16384
    ds_read_b64_tr_b16 v[30:31], v4 offset:17408
    v_mfma_f32_16x16x32_bf16 v[76:79], v[20:23], v[124:127], v[76:79]
    v_add_f32 v161, v161, v206
    v_mfma_f32_16x16x32_bf16 v[84:87], v[20:23], v[112:115], v[84:87]
    v_lshlrev_b32 v162, 16, v201
    v_and_b32 v163, 0xffff0000, v201
    v_mfma_f32_16x16x32_bf16 v[92:95], v[20:23], v[116:119], v[92:95]
    v_add_f32 v162, v162, v206
    v_add_f32 v163, v163, v206
    s_waitcnt lgkmcnt(2)
    v_mfma_f32_16x16x32_bf16 v[64:67], v[24:27], v[136:139], v[64:67]
    v_lshlrev_b32 v164, 16, v202
    v_and_b32 v165, 0xffff0000, v202
    v_mfma_f32_16x16x32_bf16 v[72:75], v[24:27], v[140:143], v[72:75]
    v_add_f32 v164, v164, v206
    v_mfma_f32_16x16x32_bf16 v[80:83], v[24:27], v[128:131], v[80:83]
    v_add_f32 v165, v165, v206
    v_lshlrev_b32 v166, 16, v203
    v_mfma_f32_16x16x32_bf16 v[88:91], v[24:27], v[132:135], v[88:91]
    s_waitcnt lgkmcnt(0)
    v_mfma_f32_16x16x32_bf16 v[68:71], v[28:31], v[136:139], v[68:71]
    v_and_b32 v167, 0xffff0000, v203
    v_add_f32 v166, v166, v206
    v_mfma_f32_16x16x32_bf16 v[76:79], v[28:31], v[140:143], v[76:79]
    v_add_f32 v167, v167, v206
    v_mfma_f32_16x16x32_bf16 v[84:87], v[28:31], v[128:131], v[84:87]
    v_mfma_f32_16x16x32_bf16 v[92:95], v[28:31], v[132:135], v[92:95]
L_join_38:
    s_nop 6
    v_cvt_pk_bf16_f32 v104, v80, v81
    v_cvt_pk_bf16_f32 v105, v82, v83
    v_cvt_pk_bf16_f32 v106, v84, v85
    v_cvt_pk_bf16_f32 v107, v86, v87
    ds_write_b128 v10, v[104:107] offset:0
    v_cvt_pk_bf16_f32 v108, v88, v89
    v_cvt_pk_bf16_f32 v109, v90, v91
    v_cvt_pk_bf16_f32 v110, v92, v93
    v_cvt_pk_bf16_f32 v111, v94, v95
    ds_write_b128 v10, v[108:111] offset:1024
    v_cvt_pk_bf16_f32 v96, v64, v65
    v_cvt_pk_bf16_f32 v97, v66, v67
    v_cvt_pk_bf16_f32 v98, v68, v69
    v_cvt_pk_bf16_f32 v99, v70, v71
    v_cvt_pk_bf16_f32 v100, v72, v73
    v_cvt_pk_bf16_f32 v101, v74, v75
    v_cvt_pk_bf16_f32 v102, v76, v77
    v_cvt_pk_bf16_f32 v103, v78, v79
    s_lshl_b32 s33, s29, 9
    s_add_u32 s33, s33, 23794688
    s_lshl_b32 s34, s28, 2
    v_lshlrev_b32 v12, 7, v0
    v_add_u32 v12, s34, v12
    v_mov_b32 v13, 1
    s_waitcnt vmcnt(0) lgkmcnt(0)
    s_barrier
    s_cmp_lg_u32 s30, 0
    s_cbranch_scc1 L_nf_39
    s_mov_b64 exec, 15
    buffer_store_dword v13, v12, s[16:19], s33 offen sc1
    s_mov_b64 exec, -1
L_nf_39:
    ds_read_b128 v[104:107], v11 offset:0
    ds_read_b128 v[108:111], v11 offset:1024
    s_add_u32 s34, s30, s28
    s_and_b32 s34, s34, 3
    s_lshl_b32 s34, s34, 7
    s_add_u32 s33, s33, s34
    v_and_b32 v12, 7, v0
    v_lshlrev_b32 v12, 2, v12
    v_mfma_f32_16x16x32_bf16 v[32:35], v[172:175], v[96:99], 0
    v_mfma_f32_16x16x32_bf16 v[36:39], v[176:179], v[96:99], 0
    v_mfma_f32_16x16x32_bf16 v[40:43], v[172:175], v[100:103], 0
    v_mfma_f32_16x16x32_bf16 v[44:47], v[176:179], v[100:103], 0
    s_waitcnt lgkmcnt(0)
    v_mfma_f32_16x16x32_bf16 v[32:35], v[172:175], v[104:107], v[32:35]
    v_mfma_f32_16x16x32_bf16 v[36:39], v[176:179], v[104:107], v[36:39]
    v_mfma_f32_16x16x32_bf16 v[40:43], v[172:175], v[108:111], v[40:43]
    v_mfma_f32_16x16x32_bf16 v[44:47], v[176:179], v[108:111], v[44:47]
    s_mov_b32 s35, 0x40000
    s_cmp_lg_u32 s30, 0
    s_cbranch_scc1 L_go_41
L_poll_40:
    buffer_load_dword v13, v12, s[16:19], s33 offen sc1
    s_sub_u32 s35, s35, 1
    s_cbranch_scc1 L_go_41
    s_waitcnt vmcnt(0)
    v_cmp_ne_u32 vcc, 1, v13
    s_cbranch_vccnz L_poll_40
L_go_41:
    s_barrier
    s_add_u32 s34, s28, 1
    s_and_b32 s34, s34, 7
    s_lshl_b32 s34, s34, 12
    s_add_u32 s34, s34, s59
    buffer_load_dwordx4 a[8:11], v1, s[16:19], s34 offen offset:0 sc1
    buffer_load_dwordx4 a[12:15], v1, s[16:19], s34 offen offset:1024 sc1
    s_add_u32 s34, s28, 2
    s_and_b32 s34, s34, 7
    s_lshl_b32 s34, s34, 12
    s_add_u32 s34, s34, s59
    buffer_load_dwordx4 a[16:19], v1, s[16:19], s34 offen offset:0 sc1
    buffer_load_dwordx4 a[20:23], v1, s[16:19], s34 offen offset:1024 sc1
    s_add_u32 s34, s28, 3
    s_and_b32 s34, s34, 7
    s_lshl_b32 s34, s34, 12
    s_add_u32 s34, s34, s59
    buffer_load_dwordx4 a[24:27], v1, s[16:19], s34 offen offset:0 sc1
    buffer_load_dwordx4 a[28:31], v1, s[16:19], s34 offen offset:1024 sc1
    s_add_u32 s34, s28, 4
    s_and_b32 s34, s34, 7
    s_lshl_b32 s34, s34, 12
    s_add_u32 s34, s34, s59
    buffer_load_dwordx4 a[32:35], v1, s[16:19], s34 offen offset:0 sc1
    buffer_load_dwordx4 a[36:39], v1, s[16:19], s34 offen offset:1024 sc1
    s_add_u32 s34, s28, 5
    s_and_b32 s34, s34, 7
    s_lshl_b32 s34, s34, 12
    s_add_u32 s34, s34, s59
    buffer_load_dwordx4 a[40:43], v1, s[16:19], s34 offen offset:0 sc1
    buffer_load_dwordx4 a[44:47], v1, s[16:19], s34 offen offset:1024 sc1
    s_add_u32 s34, s28, 6
    s_and_b32 s34, s34, 7
    s_lshl_b32 s34, s34, 12
    s_add_u32 s34, s34, s59
    buffer_load_dwordx4 a[48:51], v1, s[16:19], s34 offen offset:0 sc1
    buffer_load_dwordx4 a[52:55], v1, s[16:19], s34 offen offset:1024 sc1
    s_add_u32 s34, s28, 7
    s_and_b32 s34, s34, 7
    s_lshl_b32 s34, s34, 12
    s_add_u32 s34, s34, s59
    buffer_load_dwordx4 a[56:59], v1, s[16:19], s34 offen offset:0 sc1
    buffer_load_dwordx4 a[60:63], v1, s[16:19], s34 offen offset:1024 sc1
    s_cmp_eq_u32 s30, 3
    s_cbranch_scc1 L_third_42
    s_waitcnt vmcnt(13)
    v_mfma_f32_16x16x32_bf16 v[32:35], v[172:175], a[8:11], v[32:35]
    v_mfma_f32_16x16x32_bf16 v[36:39], v[176:179], a[8:11], v[36:39]
    s_waitcnt vmcnt(12)
    v_mfma_f32_16x16x32_bf16 v[40:43], v[172:175], a[12:15], v[40:43]
    v_mfma_f32_16x16x32_bf16 v[44:47], v[176:179], a[12:15], v[44:47]
    s_waitcnt vmcnt(11)
    v_mfma_f32_16x16x32_bf16 v[32:35], v[172:175], a[16:19], v[32:35]
    v_mfma_f32_16x16x32_bf16 v[36:39], v[176:179], a[16:19], v[36:39]
    s_waitcnt vmcnt(10)
    v_mfma_f32_16x16x32_bf16 v[40:43], v[172:175], a[20:23], v[40:43]
    v_mfma_f32_16x16x32_bf16 v[44:47], v[176:179], a[20:23], v[44:47]
    s_waitcnt vmcnt(9)
    v_mfma_f32_16x16x32_bf16 v[32:35], v[172:175], a[24:27], v[32:35]
    v_mfma_f32_16x16x32_bf16 v[36:39], v[176:179], a[24:27], v[36:39]
    s_waitcnt vmcnt(8)
    v_mfma_f32_16x16x32_bf16 v[40:43], v[172:175], a[28:31], v[40:43]
    v_mfma_f32_16x16x32_bf16 v[44:47], v[176:179], a[28:31], v[44:47]
    s_waitcnt vmcnt(7)
    v_mfma_f32_16x16x32_bf16 v[32:35], v[172:175], a[32:35], v[32:35]
    v_mfma_f32_16x16x32_bf16 v[36:39], v[176:179], a[32:35], v[36:39]
    s_waitcnt vmcnt(6)
    v_mfma_f32_16x16x32_bf16 v[40:43], v[172:175], a[36:39], v[40:43]
    v_mfma_f32_16x16x32_bf16 v[44:47], v[176:179], a[36:39], v[44:47]
    s_waitcnt vmcnt(5)
    v_mfma_f32_16x16x32_bf16 v[32:35], v[172:175], a[40:43], v[32:35]
    v_mfma_f32_16x16x32_bf16 v[36:39], v[176:179], a[40:43], v[36:39]
    s_waitcnt vmcnt(4)
    v_mfma_f32_16x16x32_bf16 v[40:43], v[172:175], a[44:47], v[40:43]
    v_mfma_f32_16x16x32_bf16 v[44:47], v[176:179], a[44:47], v[44:47]
    s_waitcnt vmcnt(3)
    v_mfma_f32_16x16x32_bf16 v[32:35], v[172:175], a[48:51], v[32:35]
    v_mfma_f32_16x16x32_bf16 v[36:39], v[176:179], a[48:51], v[36:39]
    s_waitcnt vmcnt(2)
    v_mfma_f32_16x16x32_bf16 v[40:43], v[172:175], a[52:55], v[40:43]
    v_mfma_f32_16x16x32_bf16 v[44:47], v[176:179], a[52:55], v[44:47]
    s_waitcnt vmcnt(1)
    v_mfma_f32_16x16x32_bf16 v[32:35], v[172:175], a[56:59], v[32:35]
    v_mfma_f32_16x16x32_bf16 v[36:39], v[176:179], a[56:59], v[36:39]
    s_waitcnt vmcnt(0)
    v_mfma_f32_16x16x32_bf16 v[40:43], v[172:175], a[60:63], v[40:43]
    v_mfma_f32_16x16x32_bf16 v[44:47], v[176:179], a[60:63], v[44:47]
    s_nop 7
    v_fma_f32 v144, v32, v168, v144
    v_fma_f32 v145, v33, v168, v145
    v_fma_f32 v146, v34, v168, v146
    v_fma_f32 v147, v35, v168, v147
    v_fma_f32 v148, v36, v168, v148
    v_fma_f32 v149, v37, v168, v149
    v_fma_f32 v150, v38, v168, v150
    v_fma_f32 v151, v39, v168, v151
    v_cvt_pk_bf16_f32 v144, v144, v145
    v_cvt_pk_bf16_f32 v145, v146, v147
    v_cvt_pk_bf16_f32 v146, v148, v149
    v_cvt_pk_bf16_f32 v147, v150, v151
    buffer_store_dwordx4 v[144:147], v14, s[20:23], s60 offen
    s_nop 7
    v_fma_f32 v152, v40, v169, v152
    v_fma_f32 v153, v41, v169, v153
    v_fma_f32 v154, v42, v169, v154
    v_fma_f32 v155, v43, v169, v155
    v_fma_f32 v156, v44, v169, v156
    v_fma_f32 v157, v45, v169, v157
    v_fma_f32 v158, v46, v169, v158
    v_fma_f32 v159, v47, v169, v159
    v_cvt_pk_bf16_f32 v152, v152, v153
    v_cvt_pk_bf16_f32 v153, v154, v155
    v_cvt_pk_bf16_f32 v154, v156, v157
    v_cvt_pk_bf16_f32 v155, v158, v159
    buffer_store_dwordx4 v[152:155], v14, s[20:23], s62 offen
    s_branch L_done_43
L_third_42:
    buffer_load_dwordx4 a[64:67], v1, s[16:19], s63 offen sc1
    s_add_u32 s63, s63, 4096
    buffer_load_dwordx4 a[68:71], v1, s[16:19], s63 offen sc1
    s_add_u32 s63, s63, 4096
    buffer_load_dwordx4 a[72:75], v1, s[16:19], s63 offen sc1
    s_add_u32 s63, s63, 4096
    buffer_load_dwordx4 a[76:79], v1, s[16:19], s63 offen sc1
    s_add_u32 s63, s63, 4096
    buffer_load_dwordx4 a[80:83], v1, s[16:19], s63 offen sc1
    s_add_u32 s63, s63, 4096
    buffer_load_dwordx4 a[84:87], v1, s[16:19], s63 offen sc1
    s_add_u32 s63, s63, 4096
    buffer_load_dwordx4 a[88:91], v1, s[16:19], s63 offen sc1
    s_add_u32 s63, s63, 4096
    buffer_load_dwordx4 a[92:95], v1, s[16:19], s63 offen sc1
    s_add_u32 s63, s63, 4096
    s_waitcnt vmcnt(21)
    v_mfma_f32_16x16x32_bf16 v[32:35], v[172:175], a[8:11], v[32:35]
    v_mfma_f32_16x16x32_bf16 v[36:39], v[176:179], a[8:11], v[36:39]
    s_waitcnt vmcnt(20)
    v_mfma_f32_16x16x32_bf16 v[40:43], v[172:175], a[12:15], v[40:43]
    v_mfma_f32_16x16x32_bf16 v[44:47], v[176:179], a[12:15], v[44:47]
    s_waitcnt vmcnt(19)
    v_mfma_f32_16x16x32_bf16 v[32:35], v[172:175], a[16:19], v[32:35]
    v_mfma_f32_16x16x32_bf16 v[36:39], v[176:179], a[16:19], v[36:39]
    s_waitcnt vmcnt(18)
    v_mfma_f32_16x16x32_bf16 v[40:43], v[172:175], a[20:23], v[40:43]
    v_mfma_f32_16x16x32_bf16 v[44:47], v[176:179], a[20:23], v[44:47]
    s_waitcnt vmcnt(17)
    v_mfma_f32_16x16x32_bf16 v[32:35], v[172:175], a[24:27], v[32:35]
    v_mfma_f32_16x16x32_bf16 v[36:39], v[176:179], a[24:27], v[36:39]
    s_waitcnt vmcnt(16)
    v_mfma_f32_16x16x32_bf16 v[40:43], v[172:175], a[28:31], v[40:43]
    v_mfma_f32_16x16x32_bf16 v[44:47], v[176:179], a[28:31], v[44:47]
    s_waitcnt vmcnt(15)
    v_mfma_f32_16x16x32_bf16 v[32:35], v[172:175], a[32:35], v[32:35]
    v_mfma_f32_16x16x32_bf16 v[36:39], v[176:179], a[32:35], v[36:39]
    s_waitcnt vmcnt(14)
    v_mfma_f32_16x16x32_bf16 v[40:43], v[172:175], a[36:39], v[40:43]
    v_mfma_f32_16x16x32_bf16 v[44:47], v[176:179], a[36:39], v[44:47]
    s_waitcnt vmcnt(13)
    v_mfma_f32_16x16x32_bf16 v[32:35], v[172:175], a[40:43], v[32:35]
    v_mfma_f32_16x16x32_bf16 v[36:39], v[176:179], a[40:43], v[36:39]
    s_waitcnt vmcnt(12)
    v_mfma_f32_16x16x32_bf16 v[40:43], v[172:175], a[44:47], v[40:43]
    v_mfma_f32_16x16x32_bf16 v[44:47], v[176:179], a[44:47], v[44:47]
    s_waitcnt vmcnt(11)
    v_mfma_f32_16x16x32_bf16 v[32:35], v[172:175], a[48:51], v[32:35]
    v_mfma_f32_16x16x32_bf16 v[36:39], v[176:179], a[48:51], v[36:39]
    s_waitcnt vmcnt(10)
    v_mfma_f32_16x16x32_bf16 v[40:43], v[172:175], a[52:55], v[40:43]
    v_mfma_f32_16x16x32_bf16 v[44:47], v[176:179], a[52:55], v[44:47]
    s_waitcnt vmcnt(9)
    v_mfma_f32_16x16x32_bf16 v[32:35], v[172:175], a[56:59], v[32:35]
    v_mfma_f32_16x16x32_bf16 v[36:39], v[176:179], a[56:59], v[36:39]
    s_waitcnt vmcnt(8)
    v_mfma_f32_16x16x32_bf16 v[40:43], v[172:175], a[60:63], v[40:43]
    v_mfma_f32_16x16x32_bf16 v[44:47], v[176:179], a[60:63], v[44:47]
    s_nop 7
    v_fma_f32 v144, v32, v168, v144
    v_fma_f32 v145, v33, v168, v145
    v_fma_f32 v146, v34, v168, v146
    v_fma_f32 v147, v35, v168, v147
    v_fma_f32 v148, v36, v168, v148
    v_fma_f32 v149, v37, v168, v149
    v_fma_f32 v150, v38, v168, v150
    v_fma_f32 v151, v39, v168, v151
    v_cvt_pk_bf16_f32 v144, v144, v145
    v_cvt_pk_bf16_f32 v145, v146, v147
    v_cvt_pk_bf16_f32 v146, v148, v149
    v_cvt_pk_bf16_f32 v147, v150, v151
    buffer_store_dwordx4 v[144:147], v14, s[20:23], s60 offen
    s_nop 7
    v_fma_f32 v152, v40, v169, v152
    v_fma_f32 v153, v41, v169, v153
    v_fma_f32 v154, v42, v169, v154
    v_fma_f32 v155, v43, v169, v155
    v_fma_f32 v156, v44, v169, v156
    v_fma_f32 v157, v45, v169, v157
    v_fma_f32 v158, v46, v169, v158
    v_fma_f32 v159, v47, v169, v159
    v_cvt_pk_bf16_f32 v152, v152, v153
    v_cvt_pk_bf16_f32 v153, v154, v155
    v_cvt_pk_bf16_f32 v154, v156, v157
    v_cvt_pk_bf16_f32 v155, v158, v159
    buffer_store_dwordx4 v[152:155], v14, s[20:23], s62 offen
    s_waitcnt vmcnt(9)
    v_mfma_f32_16x16x32_bf16 v[48:51], v[172:175], a[64:67], 0
    v_mfma_f32_16x16x32_bf16 v[52:55], v[176:179], a[64:67], 0
    s_waitcnt vmcnt(8)
    v_mfma_f32_16x16x32_bf16 v[48:51], v[172:175], a[68:71], v[48:51]
    v_mfma_f32_16x16x32_bf16 v[52:55], v[176:179], a[68:71], v[52:55]
    s_waitcnt vmcnt(7)
    v_mfma_f32_16x16x32_bf16 v[48:51], v[172:175], a[72:75], v[48:51]
    v_mfma_f32_16x16x32_bf16 v[52:55], v[176:179], a[72:75], v[52:55]
    s_waitcnt vmcnt(6)
    v_mfma_f32_16x16x32_bf16 v[48:51], v[172:175], a[76:79], v[48:51]
    v_mfma_f32_16x16x32_bf16 v[52:55], v[176:179], a[76:79], v[52:55]
    s_waitcnt vmcnt(5)
    v_mfma_f32_16x16x32_bf16 v[48:51], v[172:175], a[80:83], v[48:51]
    v_mfma_f32_16x16x32_bf16 v[52:55], v[176:179], a[80:83], v[52:55]
    s_waitcnt vmcnt(4)
    v_mfma_f32_16x16x32_bf16 v[48:51], v[172:175], a[84:87], v[48:51]
    v_mfma_f32_16x16x32_bf16 v[52:55], v[176:179], a[84:87], v[52:55]
    s_waitcnt vmcnt(3)
    v_mfma_f32_16x16x32_bf16 v[48:51], v[172:175], a[88:91], v[48:51]
    v_mfma_f32_16x16x32_bf16 v[52:55], v[176:179], a[88:91], v[52:55]
    s_waitcnt vmcnt(2)
    v_mfma_f32_16x16x32_bf16 v[48:51], v[172:175], a[92:95], v[48:51]
    v_mfma_f32_16x16x32_bf16 v[52:55], v[176:179], a[92:95], v[52:55]
    s_nop 7
    v_fma_f32 v160, v48, v170, v160
    v_fma_f32 v161, v49, v170, v161
    v_fma_f32 v162, v50, v170, v162
    v_fma_f32 v163, v51, v170, v163
    v_fma_f32 v164, v52, v170, v164
    v_fma_f32 v165, v53, v170, v165
    v_fma_f32 v166, v54, v170, v166
    v_fma_f32 v167, v55, v170, v167
    v_cvt_pk_bf16_f32 v160, v160, v161
    v_cvt_pk_bf16_f32 v161, v162, v163
    v_cvt_pk_bf16_f32 v162, v164, v165
    v_cvt_pk_bf16_f32 v163, v166, v167
    buffer_store_dwordx4 v[160:163], v14, s[20:23], s64 offen
L_done_43:
L_exit_32:
    s_endpgm
.section .rodata,"a"
.p2align 6
.amdhsa_kernel qkv_kernel
  .amdhsa_next_free_vgpr 240
  .amdhsa_next_free_sgpr 102
  .amdhsa_accum_offset 240
  .amdhsa_group_segment_fixed_size 0
  .amdhsa_kernarg_size 72
  .amdhsa_user_sgpr_count 2
  .amdhsa_user_sgpr_kernarg_segment_ptr 1
  .amdhsa_system_sgpr_workgroup_id_x 1
  .amdhsa_float_denorm_mode_32 3
.end_amdhsa_kernel
.p2align 6
.amdhsa_kernel sequential_preLN__linear_attn_block__dense_activation_relu__prompt_kernel
  .amdhsa_next_free_vgpr 512
  .amdhsa_next_free_sgpr 102
  .amdhsa_accum_offset 256
  .amdhsa_group_segment_fixed_size 0
  .amdhsa_kernarg_size 72
  .amdhsa_user_sgpr_count 2
  .amdhsa_user_sgpr_kernarg_segment_ptr 1
  .amdhsa_system_sgpr_workgroup_id_x 1
  .amdhsa_float_denorm_mode_32 3
.end_amdhsa_kernel
```
